```python
import torch

def _softmax(x, axis=-1):
    return torch.softmax(x, dim=axis)

def _gelu(x):
    return torch.nn.functional.gelu(x, approximate='tanh')

def _silu(x):
    return torch.nn.functional.silu(x)

def _sigmoid(x):
    return torch.sigmoid(x)

def _layernorm(x, axis=-1, eps=1e-05):
    m = x.mean(dim=axis, keepdim=True)
    v = x.var(dim=axis, keepdim=True, unbiased=False)
    return (x - m) / torch.sqrt(v + eps)

def _scatter_add(tgt, idx, src, axis=0):
    return tgt.clone().index_add_(axis, idx, src)

def _segment_sum(src, seg, n):
    out = torch.zeros((n,) + src.shape[1:], dtype=src.dtype)
    return out.index_add_(0, seg, src)

def _pad(x, pw):
    flat = tuple((v for pair in reversed(pw) for v in pair))
    return torch.nn.functional.pad(x, flat)
kernel_name = 'standalone__mixer_gmlp__prompt'

def setup_inputs():

    _w = lambda a: (lambda t: t.to(torch.bfloat16) if t.is_floating_point() else t)(torch.as_tensor(a))
    B, S, D, F = (1, 2048, 448, 1792)
    Fh = F // 2
    return {'x': _w((lambda *s: torch.randn(*s, dtype=torch.bfloat16) * 0.05)(B, S, D)), 'w_in': _w((lambda *s: torch.randn(*s, dtype=torch.bfloat16) * 0.4)(D, 2 * Fh)), 'w_sp': _w(0.01 * (lambda *s: torch.randn(*s, dtype=torch.bfloat16) * 0.4)(S, S)), 'b_sp': _w(1.0 + 0.01 * (lambda *s: torch.randn(*s, dtype=torch.bfloat16) * 0.05)(S)), 'w_out': _w((lambda *s: torch.randn(*s, dtype=torch.bfloat16) * 0.05)(Fh, D))}

def reference(x, w_in, w_sp, b_sp, w_out):
    B, S, D = x.shape
    F = w_in.shape[-1]
    Fh = F // 2
    z = _gelu(torch.einsum('bsd,df->bsf', x, w_in))
    z1 = z[..., :Fh].clone()
    z2 = _layernorm(z[..., Fh:], axis=-1)
    g = torch.einsum('ts,bsf->btf', w_sp, z2) + b_sp[None, :, None]
    return torch.einsum('bsf,fd->bsd', z1 * g, w_out)
```

```asm
; @launch kernel=gemm1_kernel grid=(256,1,1) block=(512,1,1) lds=163840
; @launch kernel=gemm2_kernel grid=(224,1,1) block=(640,1,1) lds=163840
; @launch kernel=gemm3_kernel grid=(224,1,1) block=(512,1,1) lds=163840
.amdgcn_target "amdgcn-amd-amdhsa--gfx950"
.text
.globl gemm1_kernel
.p2align 8
.type gemm1_kernel,@function
gemm1_kernel:
  s_cmp_ge_u32 s2, 256
  s_cbranch_scc1 gemm1_kernel_end
  s_cmp_ge_u32 s2, 224
  s_cbranch_scc1 gemm1_kernel_pf
  s_load_dwordx16 s[32:47], s[0:1], 0
  s_and_b32 s56, s2, 7
  s_lshr_b32 s57, s2, 3
  s_and_b32 s48, s57, 3
  s_lshr_b32 s49, s57, 2
  s_lshr_b32 s58, s56, 1
  s_lshl_b32 s58, s58, 2
  s_add_u32 s48, s48, s58
  s_and_b32 s58, s56, 1
  s_mul_i32 s58, s58, 7
  s_add_u32 s49, s49, s58
  v_and_b32 v1, 63, v0
  v_lshrrev_b32 v2, 6, v0
  s_nop 0
  v_readfirstlane_b32 s50, v2
  v_and_b32 v2, 3, v2
  s_mov_b32 s59, s50
  s_cmp_lt_u32 s50, 4
  s_cbranch_scc1 gemm1_kernel_cons
  s_sub_u32 s50, s50, 4
  s_mul_i32 s56, s48, 114688
  s_mov_b32 s57, 896
  v_lshrrev_b32 v3, 3, v1
  v_mul_u32_u24 v4, 32, v2
  v_add3_u32 v3, v3, v4, 0
  v_bfe_u32 v4, v3, 1, 3
  v_and_b32 v5, 7, v1
  v_xor_b32 v5, v5, v4
  v_lshlrev_b32 v5, 4, v5
  v_mul_lo_u32 v3, v3, s57
  v_add3_u32 v11, v3, v5, s56
  v_lshrrev_b32 v3, 3, v1
  v_mul_u32_u24 v4, 32, v2
  v_add3_u32 v3, v3, v4, 8
  v_bfe_u32 v4, v3, 1, 3
  v_and_b32 v5, 7, v1
  v_xor_b32 v5, v5, v4
  v_lshlrev_b32 v5, 4, v5
  v_mul_lo_u32 v3, v3, s57
  v_add3_u32 v12, v3, v5, s56
  v_lshrrev_b32 v3, 3, v1
  v_mul_u32_u24 v4, 32, v2
  v_add3_u32 v3, v3, v4, 16
  v_bfe_u32 v4, v3, 1, 3
  v_and_b32 v5, 7, v1
  v_xor_b32 v5, v5, v4
  v_lshlrev_b32 v5, 4, v5
  v_mul_lo_u32 v3, v3, s57
  v_add3_u32 v13, v3, v5, s56
  v_lshrrev_b32 v3, 3, v1
  v_mul_u32_u24 v4, 32, v2
  v_add3_u32 v3, v3, v4, 24
  v_bfe_u32 v4, v3, 1, 3
  v_and_b32 v5, 7, v1
  v_xor_b32 v5, v5, v4
  v_lshlrev_b32 v5, 4, v5
  v_mul_lo_u32 v3, v3, s57
  v_add3_u32 v14, v3, v5, s56
  s_mul_i32 s56, s49, 256
  s_mov_b32 s57, 3584
  v_lshrrev_b32 v3, 4, v1
  v_mul_u32_u24 v4, 16, v2
  v_add3_u32 v3, v3, v4, 0
  v_and_b32 v4, 3, v3
  v_lshlrev_b32 v4, 2, v4
  v_and_b32 v5, 15, v1
  v_xor_b32 v5, v5, v4
  v_lshlrev_b32 v5, 4, v5
  v_mul_lo_u32 v3, v3, s57
  v_add3_u32 v15, v3, v5, s56
  v_lshrrev_b32 v3, 4, v1
  v_mul_u32_u24 v4, 16, v2
  v_add3_u32 v3, v3, v4, 4
  v_and_b32 v4, 3, v3
  v_lshlrev_b32 v4, 2, v4
  v_and_b32 v5, 15, v1
  v_xor_b32 v5, v5, v4
  v_lshlrev_b32 v5, 4, v5
  v_mul_lo_u32 v3, v3, s57
  v_add3_u32 v16, v3, v5, s56
  v_lshrrev_b32 v3, 4, v1
  v_mul_u32_u24 v4, 16, v2
  v_add3_u32 v3, v3, v4, 8
  v_and_b32 v4, 3, v3
  v_lshlrev_b32 v4, 2, v4
  v_and_b32 v5, 15, v1
  v_xor_b32 v5, v5, v4
  v_lshlrev_b32 v5, 4, v5
  v_mul_lo_u32 v3, v3, s57
  v_add3_u32 v17, v3, v5, s56
  v_lshrrev_b32 v3, 4, v1
  v_mul_u32_u24 v4, 16, v2
  v_add3_u32 v3, v3, v4, 12
  v_and_b32 v4, 3, v3
  v_lshlrev_b32 v4, 2, v4
  v_and_b32 v5, 15, v1
  v_xor_b32 v5, v5, v4
  v_lshlrev_b32 v5, 4, v5
  v_mul_lo_u32 v3, v3, s57
  v_add3_u32 v18, v3, v5, s56
  s_mul_i32 s53, s50, 4096
  s_mul_i32 s54, s50, 4096
  s_add_u32 s54, s54, 81920
  s_mov_b32 s51, 0
  s_mov_b32 s52, 0
  s_waitcnt lgkmcnt(0)
  s_mov_b32 s8, s32
  s_mov_b32 s9, s33
  s_and_b32 s9, s9, 0xffff
  s_mov_b32 s10, 0x1c0000
  s_mov_b32 s11, 0x20000
  s_mov_b32 s12, s34
  s_mov_b32 s13, s35
  s_and_b32 s13, s13, 0xffff
  s_mov_b32 s14, 0x188000
  s_mov_b32 s15, 0x20000
  s_add_u32 s24, s46, 0x800000
  s_addc_u32 s25, s47, 0
  s_and_b32 s25, s25, 0xffff
  s_mov_b32 s26, 0x1c000
  s_mov_b32 s27, 0x20000
  s_mov_b32 s16, s46
  s_mov_b32 s17, s47
  s_and_b32 s17, s17, 0xffff
  s_mov_b32 s18, 0x700000
  s_mov_b32 s19, 0x20000
  s_add_u32 m0, s53, 0
  s_nop 0
  buffer_load_dwordx4 v11, s[8:11], s51 offen lds
  s_add_u32 m0, s53, 1024
  s_nop 0
  buffer_load_dwordx4 v12, s[8:11], s51 offen lds
  s_add_u32 m0, s53, 2048
  s_nop 0
  buffer_load_dwordx4 v13, s[8:11], s51 offen lds
  s_add_u32 m0, s53, 3072
  s_nop 0
  buffer_load_dwordx4 v14, s[8:11], s51 offen lds
  s_add_u32 s51, s51, 128
  s_add_u32 m0, s54, 0
  s_nop 0
  buffer_load_dwordx4 v15, s[12:15], s52 offen lds
  s_add_u32 m0, s54, 1024
  s_nop 0
  buffer_load_dwordx4 v16, s[12:15], s52 offen lds
  s_add_u32 m0, s54, 2048
  s_nop 0
  buffer_load_dwordx4 v17, s[12:15], s52 offen lds
  s_add_u32 m0, s54, 3072
  s_nop 0
  buffer_load_dwordx4 v18, s[12:15], s52 offen lds
  s_add_u32 s52, s52, 229376
  s_add_u32 m0, s53, 16384
  s_nop 0
  buffer_load_dwordx4 v11, s[8:11], s51 offen lds
  s_add_u32 m0, s53, 17408
  s_nop 0
  buffer_load_dwordx4 v12, s[8:11], s51 offen lds
  s_add_u32 m0, s53, 18432
  s_nop 0
  buffer_load_dwordx4 v13, s[8:11], s51 offen lds
  s_add_u32 m0, s53, 19456
  s_nop 0
  buffer_load_dwordx4 v14, s[8:11], s51 offen lds
  s_add_u32 s51, s51, 128
  s_add_u32 m0, s54, 16384
  s_nop 0
  buffer_load_dwordx4 v15, s[12:15], s52 offen lds
  s_add_u32 m0, s54, 17408
  s_nop 0
  buffer_load_dwordx4 v16, s[12:15], s52 offen lds
  s_add_u32 m0, s54, 18432
  s_nop 0
  buffer_load_dwordx4 v17, s[12:15], s52 offen lds
  s_add_u32 m0, s54, 19456
  s_nop 0
  buffer_load_dwordx4 v18, s[12:15], s52 offen lds
  s_add_u32 s52, s52, 229376
  s_add_u32 m0, s53, 32768
  s_nop 0
  buffer_load_dwordx4 v11, s[8:11], s51 offen lds
  s_add_u32 m0, s53, 33792
  s_nop 0
  buffer_load_dwordx4 v12, s[8:11], s51 offen lds
  s_add_u32 m0, s53, 34816
  s_nop 0
  buffer_load_dwordx4 v13, s[8:11], s51 offen lds
  s_add_u32 m0, s53, 35840
  s_nop 0
  buffer_load_dwordx4 v14, s[8:11], s51 offen lds
  s_add_u32 s51, s51, 128
  s_add_u32 m0, s54, 32768
  s_nop 0
  buffer_load_dwordx4 v15, s[12:15], s52 offen lds
  s_add_u32 m0, s54, 33792
  s_nop 0
  buffer_load_dwordx4 v16, s[12:15], s52 offen lds
  s_add_u32 m0, s54, 34816
  s_nop 0
  buffer_load_dwordx4 v17, s[12:15], s52 offen lds
  s_add_u32 m0, s54, 35840
  s_nop 0
  buffer_load_dwordx4 v18, s[12:15], s52 offen lds
  s_add_u32 s52, s52, 229376
  s_add_u32 m0, s53, 49152
  s_nop 0
  buffer_load_dwordx4 v11, s[8:11], s51 offen lds
  s_add_u32 m0, s53, 50176
  s_nop 0
  buffer_load_dwordx4 v12, s[8:11], s51 offen lds
  s_add_u32 m0, s53, 51200
  s_nop 0
  buffer_load_dwordx4 v13, s[8:11], s51 offen lds
  s_add_u32 m0, s53, 52224
  s_nop 0
  buffer_load_dwordx4 v14, s[8:11], s51 offen lds
  s_add_u32 s51, s51, 128
  s_add_u32 m0, s54, 49152
  s_nop 0
  buffer_load_dwordx4 v15, s[12:15], s52 offen lds
  s_add_u32 m0, s54, 50176
  s_nop 0
  buffer_load_dwordx4 v16, s[12:15], s52 offen lds
  s_add_u32 m0, s54, 51200
  s_nop 0
  buffer_load_dwordx4 v17, s[12:15], s52 offen lds
  s_add_u32 m0, s54, 52224
  s_nop 0
  buffer_load_dwordx4 v18, s[12:15], s52 offen lds
  s_add_u32 s52, s52, 229376
  s_add_u32 m0, s53, 65536
  s_nop 0
  buffer_load_dwordx4 v11, s[8:11], s51 offen lds
  s_add_u32 m0, s53, 66560
  s_nop 0
  buffer_load_dwordx4 v12, s[8:11], s51 offen lds
  s_add_u32 m0, s53, 67584
  s_nop 0
  buffer_load_dwordx4 v13, s[8:11], s51 offen lds
  s_add_u32 m0, s53, 68608
  s_nop 0
  buffer_load_dwordx4 v14, s[8:11], s51 offen lds
  s_add_u32 s51, s51, 128
  s_add_u32 m0, s54, 65536
  s_nop 0
  buffer_load_dwordx4 v15, s[12:15], s52 offen lds
  s_add_u32 m0, s54, 66560
  s_nop 0
  buffer_load_dwordx4 v16, s[12:15], s52 offen lds
  s_add_u32 m0, s54, 67584
  s_nop 0
  buffer_load_dwordx4 v17, s[12:15], s52 offen lds
  s_add_u32 m0, s54, 68608
  s_nop 0
  buffer_load_dwordx4 v18, s[12:15], s52 offen lds
  s_add_u32 s52, s52, 229376
  v_lshrrev_b32 v7, 4, v0
  v_and_b32 v3, 15, v0
  v_mul_u32_u24 v4, 528, v7
  v_lshl_add_u32 v8, v3, 5, v4
  s_mul_i32 s56, s48, 128
  v_add_u32 v4, s56, v7
  s_mov_b32 s57, 3584
  v_mul_lo_u32 v5, v4, s57
  s_mul_i32 s56, s49, 256
  v_lshl_add_u32 v6, v3, 4, v5
  v_add_u32 v9, s56, v6
  s_sub_u32 s56, s49, 7
  s_lshl_b32 s56, s56, 11
  v_add_u32 v5, s56, v4
  v_lshlrev_b32 v10, 3, v5
  s_waitcnt vmcnt(24)
  s_barrier
  s_waitcnt vmcnt(16)
  s_barrier
  s_add_u32 m0, s53, 0
  s_nop 0
  buffer_load_dwordx4 v11, s[8:11], s51 offen lds
  s_add_u32 m0, s53, 1024
  s_nop 0
  buffer_load_dwordx4 v12, s[8:11], s51 offen lds
  s_add_u32 m0, s53, 2048
  s_nop 0
  buffer_load_dwordx4 v13, s[8:11], s51 offen lds
  s_add_u32 m0, s53, 3072
  s_nop 0
  buffer_load_dwordx4 v14, s[8:11], s51 offen lds
  s_add_u32 s51, s51, 128
  s_add_u32 m0, s54, 0
  s_nop 0
  buffer_load_dwordx4 v15, s[12:15], s52 offen lds
  s_add_u32 m0, s54, 1024
  s_nop 0
  buffer_load_dwordx4 v16, s[12:15], s52 offen lds
  s_add_u32 m0, s54, 2048
  s_nop 0
  buffer_load_dwordx4 v17, s[12:15], s52 offen lds
  s_add_u32 m0, s54, 3072
  s_nop 0
  buffer_load_dwordx4 v18, s[12:15], s52 offen lds
  s_add_u32 s52, s52, 229376
  s_waitcnt vmcnt(16)
  s_barrier
  s_add_u32 m0, s53, 16384
  s_nop 0
  buffer_load_dwordx4 v11, s[8:11], s51 offen lds
  s_add_u32 m0, s53, 17408
  s_nop 0
  buffer_load_dwordx4 v12, s[8:11], s51 offen lds
  s_add_u32 m0, s53, 18432
  s_nop 0
  buffer_load_dwordx4 v13, s[8:11], s51 offen lds
  s_add_u32 m0, s53, 19456
  s_nop 0
  buffer_load_dwordx4 v14, s[8:11], s51 offen lds
  s_add_u32 s51, s51, 128
  s_add_u32 m0, s54, 16384
  s_nop 0
  buffer_load_dwordx4 v15, s[12:15], s52 offen lds
  s_add_u32 m0, s54, 17408
  s_nop 0
  buffer_load_dwordx4 v16, s[12:15], s52 offen lds
  s_add_u32 m0, s54, 18432
  s_nop 0
  buffer_load_dwordx4 v17, s[12:15], s52 offen lds
  s_add_u32 m0, s54, 19456
  s_nop 0
  buffer_load_dwordx4 v18, s[12:15], s52 offen lds
  s_add_u32 s52, s52, 229376
  s_waitcnt vmcnt(16)
  s_barrier
  s_waitcnt vmcnt(8)
  v_subrev_u32 v19, 256, v0
  v_lshlrev_b32 v19, 4, v19
  s_mov_b32 s20, s36
  s_mov_b32 s21, s37
  s_and_b32 s21, s21, 0xffff
  s_mov_b32 s22, 0x800000
  s_mov_b32 s23, 0x20000
  s_mov_b32 s28, s40
  s_mov_b32 s29, s41
  s_and_b32 s29, s29, 0xffff
  s_mov_b32 s30, 0xc4000
  s_mov_b32 s31, 0x20000
  s_lshl_b32 s56, s2, 15
  s_mul_i32 s57, s2, 3136
  buffer_load_dwordx4 v[160:163], v19, s[20:23], s56 offen
  s_add_u32 s56, s56, 4096
  buffer_load_dwordx4 v[164:167], v19, s[20:23], s56 offen
  s_add_u32 s56, s56, 4096
  buffer_load_dwordx4 v[160:163], v19, s[20:23], s56 offen
  s_add_u32 s56, s56, 4096
  buffer_load_dwordx4 v[164:167], v19, s[20:23], s56 offen
  s_add_u32 s56, s56, 4096
  buffer_load_dwordx4 v[160:163], v19, s[20:23], s56 offen
  s_add_u32 s56, s56, 4096
  buffer_load_dwordx4 v[164:167], v19, s[20:23], s56 offen
  s_add_u32 s56, s56, 4096
  buffer_load_dwordx4 v[160:163], v19, s[20:23], s56 offen
  s_add_u32 s56, s56, 4096
  buffer_load_dwordx4 v[164:167], v19, s[20:23], s56 offen
  s_add_u32 s56, s56, 4096
  buffer_load_dwordx4 v[160:163], v19, s[28:31], s57 offen
  s_barrier
  s_waitcnt vmcnt(9)
  s_barrier
  s_barrier
  s_barrier
  s_branch gemm1_kernel_epi
gemm1_kernel_cons:
  v_lshrrev_b32 v11, 1, v2
  v_and_b32 v12, 1, v2
  s_waitcnt lgkmcnt(0)
  s_mov_b32 s16, s46
  s_mov_b32 s17, s47
  s_and_b32 s17, s17, 0xffff
  s_mov_b32 s18, 0x700000
  s_mov_b32 s19, 0x20000
  s_add_u32 s24, s46, 0x800000
  s_addc_u32 s25, s47, 0
  s_and_b32 s25, s25, 0xffff
  s_mov_b32 s26, 0x1c000
  s_mov_b32 s27, 0x20000
  v_lshrrev_b32 v7, 4, v0
  v_and_b32 v3, 15, v0
  v_mul_u32_u24 v4, 528, v7
  v_lshl_add_u32 v8, v3, 5, v4
  s_mul_i32 s56, s48, 128
  v_add_u32 v4, s56, v7
  s_mov_b32 s57, 3584
  v_mul_lo_u32 v5, v4, s57
  s_mul_i32 s56, s49, 256
  v_lshl_add_u32 v6, v3, 4, v5
  v_add_u32 v9, s56, v6
  s_sub_u32 s56, s49, 7
  s_lshl_b32 s56, s56, 11
  v_add_u32 v5, s56, v4
  v_lshlrev_b32 v10, 3, v5
  v_and_b32 v3, 31, v1
  v_mul_u32_u24 v4, 64, v11
  v_add_u32 v3, v3, v4
  v_mul_u32_u24 v129, 528, v3
  v_mul_u32_u24 v5, 256, v12
  v_add_u32 v129, v129, v5
  v_lshrrev_b32 v5, 5, v1
  v_lshl_add_u32 v129, v5, 4, v129
  v_bfe_u32 v4, v3, 1, 3
  v_lshrrev_b32 v5, 5, v1
  v_xor_b32 v5, v5, v4
  v_lshlrev_b32 v5, 4, v5
  v_lshlrev_b32 v3, 7, v3
  v_add_u32 v128, v3, v5
  v_lshrrev_b32 v3, 5, v1
  v_lshlrev_b32 v3, 3, v3
  v_bfe_u32 v4, v1, 2, 2
  v_add_u32 v3, v3, v4
  v_lshlrev_b32 v4, 2, v4
  v_mul_u32_u24 v5, 8, v12
  v_bfe_u32 v6, v1, 4, 1
  v_lshl_add_u32 v5, v6, 1, v5
  v_bfe_u32 v6, v1, 1, 1
  v_add_u32 v5, v5, v6
  v_xor_b32 v5, v5, v4
  v_lshlrev_b32 v5, 4, v5
  v_lshlrev_b32 v3, 8, v3
  v_add_u32 v3, v3, v5
  v_and_b32 v6, 1, v1
  v_lshl_add_u32 v130, v6, 3, v3
  v_add_u32 v130, 81920, v130
  v_xor_b32 v131, 0, v128
  v_xor_b32 v132, 32, v128
  v_xor_b32 v133, 64, v128
  v_xor_b32 v134, 96, v128
  v_xor_b32 v135, 0, v128
  v_add_u32 v135, 16384, v135
  v_xor_b32 v136, 32, v128
  v_add_u32 v136, 16384, v136
  v_xor_b32 v137, 64, v128
  v_add_u32 v137, 16384, v137
  v_xor_b32 v138, 96, v128
  v_add_u32 v138, 16384, v138
  v_xor_b32 v139, 0, v128
  v_add_u32 v139, 32768, v139
  v_xor_b32 v140, 32, v128
  v_add_u32 v140, 32768, v140
  v_xor_b32 v141, 64, v128
  v_add_u32 v141, 32768, v141
  v_xor_b32 v142, 96, v128
  v_add_u32 v142, 32768, v142
  v_xor_b32 v143, 0, v128
  v_add_u32 v143, 49152, v143
  v_xor_b32 v144, 32, v128
  v_add_u32 v144, 49152, v144
  v_xor_b32 v145, 64, v128
  v_add_u32 v145, 49152, v145
  v_xor_b32 v146, 96, v128
  v_add_u32 v146, 49152, v146
  v_xor_b32 v147, 0, v128
  v_add_u32 v147, 65536, v147
  v_xor_b32 v148, 32, v128
  v_add_u32 v148, 65536, v148
  v_xor_b32 v149, 64, v128
  v_add_u32 v149, 65536, v149
  v_xor_b32 v150, 96, v128
  v_add_u32 v150, 65536, v150
  v_xor_b32 v151, 0, v130
  v_xor_b32 v152, 64, v130
  v_xor_b32 v153, 0, v130
  v_add_u32 v153, 16384, v153
  v_xor_b32 v154, 64, v130
  v_add_u32 v154, 16384, v154
  v_xor_b32 v155, 0, v130
  v_add_u32 v155, 32768, v155
  v_xor_b32 v156, 64, v130
  v_add_u32 v156, 32768, v156
  v_xor_b32 v157, 0, v130
  v_add_u32 v157, 49152, v157
  v_xor_b32 v158, 64, v130
  v_add_u32 v158, 49152, v158
  v_xor_b32 v159, 0, v130
  v_add_u32 v159, 65536, v159
  v_xor_b32 v160, 64, v130
  v_add_u32 v160, 65536, v160
  v_mov_b32 v16, 0
  v_mov_b32 v17, 0
  v_mov_b32 v18, 0
  v_mov_b32 v19, 0
  v_mov_b32 v20, 0
  v_mov_b32 v21, 0
  v_mov_b32 v22, 0
  v_mov_b32 v23, 0
  v_mov_b32 v24, 0
  v_mov_b32 v25, 0
  v_mov_b32 v26, 0
  v_mov_b32 v27, 0
  v_mov_b32 v28, 0
  v_mov_b32 v29, 0
  v_mov_b32 v30, 0
  v_mov_b32 v31, 0
  v_mov_b32 v32, 0
  v_mov_b32 v33, 0
  v_mov_b32 v34, 0
  v_mov_b32 v35, 0
  v_mov_b32 v36, 0
  v_mov_b32 v37, 0
  v_mov_b32 v38, 0
  v_mov_b32 v39, 0
  v_mov_b32 v40, 0
  v_mov_b32 v41, 0
  v_mov_b32 v42, 0
  v_mov_b32 v43, 0
  v_mov_b32 v44, 0
  v_mov_b32 v45, 0
  v_mov_b32 v46, 0
  v_mov_b32 v47, 0
  v_mov_b32 v48, 0
  v_mov_b32 v49, 0
  v_mov_b32 v50, 0
  v_mov_b32 v51, 0
  v_mov_b32 v52, 0
  v_mov_b32 v53, 0
  v_mov_b32 v54, 0
  v_mov_b32 v55, 0
  v_mov_b32 v56, 0
  v_mov_b32 v57, 0
  v_mov_b32 v58, 0
  v_mov_b32 v59, 0
  v_mov_b32 v60, 0
  v_mov_b32 v61, 0
  v_mov_b32 v62, 0
  v_mov_b32 v63, 0
  v_mov_b32 v64, 0
  v_mov_b32 v65, 0
  v_mov_b32 v66, 0
  v_mov_b32 v67, 0
  v_mov_b32 v68, 0
  v_mov_b32 v69, 0
  v_mov_b32 v70, 0
  v_mov_b32 v71, 0
  v_mov_b32 v72, 0
  v_mov_b32 v73, 0
  v_mov_b32 v74, 0
  v_mov_b32 v75, 0
  v_mov_b32 v76, 0
  v_mov_b32 v77, 0
  v_mov_b32 v78, 0
  v_mov_b32 v79, 0
  s_barrier
  ds_read_b64_tr_b16 v[104:105], v151 offset:0
  ds_read_b64_tr_b16 v[106:107], v151 offset:1024
  ds_read_b64_tr_b16 v[108:109], v152 offset:0
  ds_read_b64_tr_b16 v[110:111], v152 offset:1024
  ds_read_b128 v[80:83], v131 offset:0
  ds_read_b128 v[84:87], v131 offset:4096
  ds_read_b64_tr_b16 v[112:113], v151 offset:4096
  ds_read_b64_tr_b16 v[114:115], v151 offset:5120
  ds_read_b64_tr_b16 v[116:117], v152 offset:4096
  ds_read_b64_tr_b16 v[118:119], v152 offset:5120
  ds_read_b128 v[88:91], v132 offset:0
  ds_read_b128 v[92:95], v132 offset:4096
  ds_read_b64_tr_b16 v[120:121], v151 offset:8192
  ds_read_b64_tr_b16 v[122:123], v151 offset:9216
  ds_read_b64_tr_b16 v[124:125], v152 offset:8192
  ds_read_b64_tr_b16 v[126:127], v152 offset:9216
  ds_read_b128 v[96:99], v133 offset:0
  ds_read_b128 v[100:103], v133 offset:4096
  s_waitcnt lgkmcnt(12)
  v_mfma_f32_32x32x16_bf16 v[16:31], v[104:107], v[80:83], v[16:31]
  v_mfma_f32_32x32x16_bf16 v[32:47], v[108:111], v[80:83], v[32:47]
  v_mfma_f32_32x32x16_bf16 v[48:63], v[104:107], v[84:87], v[48:63]
  v_mfma_f32_32x32x16_bf16 v[64:79], v[108:111], v[84:87], v[64:79]
  ds_read_b64_tr_b16 v[104:105], v151 offset:12288
  ds_read_b64_tr_b16 v[106:107], v151 offset:13312
  ds_read_b64_tr_b16 v[108:109], v152 offset:12288
  ds_read_b64_tr_b16 v[110:111], v152 offset:13312
  ds_read_b128 v[80:83], v134 offset:0
  ds_read_b128 v[84:87], v134 offset:4096
  s_waitcnt lgkmcnt(12)
  v_mfma_f32_32x32x16_bf16 v[16:31], v[112:115], v[88:91], v[16:31]
  v_mfma_f32_32x32x16_bf16 v[32:47], v[116:119], v[88:91], v[32:47]
  v_mfma_f32_32x32x16_bf16 v[48:63], v[112:115], v[92:95], v[48:63]
  v_mfma_f32_32x32x16_bf16 v[64:79], v[116:119], v[92:95], v[64:79]
  ds_read_b64_tr_b16 v[112:113], v153 offset:0
  ds_read_b64_tr_b16 v[114:115], v153 offset:1024
  ds_read_b64_tr_b16 v[116:117], v154 offset:0
  ds_read_b64_tr_b16 v[118:119], v154 offset:1024
  ds_read_b128 v[88:91], v135 offset:0
  ds_read_b128 v[92:95], v135 offset:4096
  s_waitcnt lgkmcnt(12)
  v_mfma_f32_32x32x16_bf16 v[16:31], v[120:123], v[96:99], v[16:31]
  v_mfma_f32_32x32x16_bf16 v[32:47], v[124:127], v[96:99], v[32:47]
  v_mfma_f32_32x32x16_bf16 v[48:63], v[120:123], v[100:103], v[48:63]
  v_mfma_f32_32x32x16_bf16 v[64:79], v[124:127], v[100:103], v[64:79]
  ds_read_b64_tr_b16 v[120:121], v153 offset:4096
  ds_read_b64_tr_b16 v[122:123], v153 offset:5120
  ds_read_b64_tr_b16 v[124:125], v154 offset:4096
  ds_read_b64_tr_b16 v[126:127], v154 offset:5120
  ds_read_b128 v[96:99], v136 offset:0
  ds_read_b128 v[100:103], v136 offset:4096
  s_waitcnt lgkmcnt(12)
  v_mfma_f32_32x32x16_bf16 v[16:31], v[104:107], v[80:83], v[16:31]
  v_mfma_f32_32x32x16_bf16 v[32:47], v[108:111], v[80:83], v[32:47]
  v_mfma_f32_32x32x16_bf16 v[48:63], v[104:107], v[84:87], v[48:63]
  v_mfma_f32_32x32x16_bf16 v[64:79], v[108:111], v[84:87], v[64:79]
  s_barrier
  ds_read_b64_tr_b16 v[104:105], v153 offset:8192
  ds_read_b64_tr_b16 v[106:107], v153 offset:9216
  ds_read_b64_tr_b16 v[108:109], v154 offset:8192
  ds_read_b64_tr_b16 v[110:111], v154 offset:9216
  ds_read_b128 v[80:83], v137 offset:0
  ds_read_b128 v[84:87], v137 offset:4096
  s_waitcnt lgkmcnt(12)
  v_mfma_f32_32x32x16_bf16 v[16:31], v[112:115], v[88:91], v[16:31]
  v_mfma_f32_32x32x16_bf16 v[32:47], v[116:119], v[88:91], v[32:47]
  v_mfma_f32_32x32x16_bf16 v[48:63], v[112:115], v[92:95], v[48:63]
  v_mfma_f32_32x32x16_bf16 v[64:79], v[116:119], v[92:95], v[64:79]
  ds_read_b64_tr_b16 v[112:113], v153 offset:12288
  ds_read_b64_tr_b16 v[114:115], v153 offset:13312
  ds_read_b64_tr_b16 v[116:117], v154 offset:12288
  ds_read_b64_tr_b16 v[118:119], v154 offset:13312
  ds_read_b128 v[88:91], v138 offset:0
  ds_read_b128 v[92:95], v138 offset:4096
  s_waitcnt lgkmcnt(12)
  v_mfma_f32_32x32x16_bf16 v[16:31], v[120:123], v[96:99], v[16:31]
  v_mfma_f32_32x32x16_bf16 v[32:47], v[124:127], v[96:99], v[32:47]
  v_mfma_f32_32x32x16_bf16 v[48:63], v[120:123], v[100:103], v[48:63]
  v_mfma_f32_32x32x16_bf16 v[64:79], v[124:127], v[100:103], v[64:79]
  ds_read_b64_tr_b16 v[120:121], v155 offset:0
  ds_read_b64_tr_b16 v[122:123], v155 offset:1024
  ds_read_b64_tr_b16 v[124:125], v156 offset:0
  ds_read_b64_tr_b16 v[126:127], v156 offset:1024
  ds_read_b128 v[96:99], v139 offset:0
  ds_read_b128 v[100:103], v139 offset:4096
  s_waitcnt lgkmcnt(12)
  v_mfma_f32_32x32x16_bf16 v[16:31], v[104:107], v[80:83], v[16:31]
  v_mfma_f32_32x32x16_bf16 v[32:47], v[108:111], v[80:83], v[32:47]
  v_mfma_f32_32x32x16_bf16 v[48:63], v[104:107], v[84:87], v[48:63]
  v_mfma_f32_32x32x16_bf16 v[64:79], v[108:111], v[84:87], v[64:79]
  ds_read_b64_tr_b16 v[104:105], v155 offset:4096
  ds_read_b64_tr_b16 v[106:107], v155 offset:5120
  ds_read_b64_tr_b16 v[108:109], v156 offset:4096
  ds_read_b64_tr_b16 v[110:111], v156 offset:5120
  ds_read_b128 v[80:83], v140 offset:0
  ds_read_b128 v[84:87], v140 offset:4096
  s_waitcnt lgkmcnt(12)
  v_mfma_f32_32x32x16_bf16 v[16:31], v[112:115], v[88:91], v[16:31]
  v_mfma_f32_32x32x16_bf16 v[32:47], v[116:119], v[88:91], v[32:47]
  v_mfma_f32_32x32x16_bf16 v[48:63], v[112:115], v[92:95], v[48:63]
  v_mfma_f32_32x32x16_bf16 v[64:79], v[116:119], v[92:95], v[64:79]
  s_barrier
  ds_read_b64_tr_b16 v[112:113], v155 offset:8192
  ds_read_b64_tr_b16 v[114:115], v155 offset:9216
  ds_read_b64_tr_b16 v[116:117], v156 offset:8192
  ds_read_b64_tr_b16 v[118:119], v156 offset:9216
  ds_read_b128 v[88:91], v141 offset:0
  ds_read_b128 v[92:95], v141 offset:4096
  s_waitcnt lgkmcnt(12)
  v_mfma_f32_32x32x16_bf16 v[16:31], v[120:123], v[96:99], v[16:31]
  v_mfma_f32_32x32x16_bf16 v[32:47], v[124:127], v[96:99], v[32:47]
  v_mfma_f32_32x32x16_bf16 v[48:63], v[120:123], v[100:103], v[48:63]
  v_mfma_f32_32x32x16_bf16 v[64:79], v[124:127], v[100:103], v[64:79]
  ds_read_b64_tr_b16 v[120:121], v155 offset:12288
  ds_read_b64_tr_b16 v[122:123], v155 offset:13312
  ds_read_b64_tr_b16 v[124:125], v156 offset:12288
  ds_read_b64_tr_b16 v[126:127], v156 offset:13312
  ds_read_b128 v[96:99], v142 offset:0
  ds_read_b128 v[100:103], v142 offset:4096
  s_waitcnt lgkmcnt(12)
  v_mfma_f32_32x32x16_bf16 v[16:31], v[104:107], v[80:83], v[16:31]
  v_mfma_f32_32x32x16_bf16 v[32:47], v[108:111], v[80:83], v[32:47]
  v_mfma_f32_32x32x16_bf16 v[48:63], v[104:107], v[84:87], v[48:63]
  v_mfma_f32_32x32x16_bf16 v[64:79], v[108:111], v[84:87], v[64:79]
  ds_read_b64_tr_b16 v[104:105], v157 offset:0
  ds_read_b64_tr_b16 v[106:107], v157 offset:1024
  ds_read_b64_tr_b16 v[108:109], v158 offset:0
  ds_read_b64_tr_b16 v[110:111], v158 offset:1024
  ds_read_b128 v[80:83], v143 offset:0
  ds_read_b128 v[84:87], v143 offset:4096
  s_waitcnt lgkmcnt(12)
  v_mfma_f32_32x32x16_bf16 v[16:31], v[112:115], v[88:91], v[16:31]
  v_mfma_f32_32x32x16_bf16 v[32:47], v[116:119], v[88:91], v[32:47]
  v_mfma_f32_32x32x16_bf16 v[48:63], v[112:115], v[92:95], v[48:63]
  v_mfma_f32_32x32x16_bf16 v[64:79], v[116:119], v[92:95], v[64:79]
  ds_read_b64_tr_b16 v[112:113], v157 offset:4096
  ds_read_b64_tr_b16 v[114:115], v157 offset:5120
  ds_read_b64_tr_b16 v[116:117], v158 offset:4096
  ds_read_b64_tr_b16 v[118:119], v158 offset:5120
  ds_read_b128 v[88:91], v144 offset:0
  ds_read_b128 v[92:95], v144 offset:4096
  s_waitcnt lgkmcnt(12)
  v_mfma_f32_32x32x16_bf16 v[16:31], v[120:123], v[96:99], v[16:31]
  v_mfma_f32_32x32x16_bf16 v[32:47], v[124:127], v[96:99], v[32:47]
  v_mfma_f32_32x32x16_bf16 v[48:63], v[120:123], v[100:103], v[48:63]
  v_mfma_f32_32x32x16_bf16 v[64:79], v[124:127], v[100:103], v[64:79]
  s_barrier
  ds_read_b64_tr_b16 v[120:121], v157 offset:8192
  ds_read_b64_tr_b16 v[122:123], v157 offset:9216
  ds_read_b64_tr_b16 v[124:125], v158 offset:8192
  ds_read_b64_tr_b16 v[126:127], v158 offset:9216
  ds_read_b128 v[96:99], v145 offset:0
  ds_read_b128 v[100:103], v145 offset:4096
  s_waitcnt lgkmcnt(12)
  v_mfma_f32_32x32x16_bf16 v[16:31], v[104:107], v[80:83], v[16:31]
  v_mfma_f32_32x32x16_bf16 v[32:47], v[108:111], v[80:83], v[32:47]
  v_mfma_f32_32x32x16_bf16 v[48:63], v[104:107], v[84:87], v[48:63]
  v_mfma_f32_32x32x16_bf16 v[64:79], v[108:111], v[84:87], v[64:79]
  ds_read_b64_tr_b16 v[104:105], v157 offset:12288
  ds_read_b64_tr_b16 v[106:107], v157 offset:13312
  ds_read_b64_tr_b16 v[108:109], v158 offset:12288
  ds_read_b64_tr_b16 v[110:111], v158 offset:13312
  ds_read_b128 v[80:83], v146 offset:0
  ds_read_b128 v[84:87], v146 offset:4096
  s_waitcnt lgkmcnt(12)
  v_mfma_f32_32x32x16_bf16 v[16:31], v[112:115], v[88:91], v[16:31]
  v_mfma_f32_32x32x16_bf16 v[32:47], v[116:119], v[88:91], v[32:47]
  v_mfma_f32_32x32x16_bf16 v[48:63], v[112:115], v[92:95], v[48:63]
  v_mfma_f32_32x32x16_bf16 v[64:79], v[116:119], v[92:95], v[64:79]
  ds_read_b64_tr_b16 v[112:113], v159 offset:0
  ds_read_b64_tr_b16 v[114:115], v159 offset:1024
  ds_read_b64_tr_b16 v[116:117], v160 offset:0
  ds_read_b64_tr_b16 v[118:119], v160 offset:1024
  ds_read_b128 v[88:91], v147 offset:0
  ds_read_b128 v[92:95], v147 offset:4096
  s_waitcnt lgkmcnt(12)
  v_mfma_f32_32x32x16_bf16 v[16:31], v[120:123], v[96:99], v[16:31]
  v_mfma_f32_32x32x16_bf16 v[32:47], v[124:127], v[96:99], v[32:47]
  v_mfma_f32_32x32x16_bf16 v[48:63], v[120:123], v[100:103], v[48:63]
  v_mfma_f32_32x32x16_bf16 v[64:79], v[124:127], v[100:103], v[64:79]
  ds_read_b64_tr_b16 v[120:121], v159 offset:4096
  ds_read_b64_tr_b16 v[122:123], v159 offset:5120
  ds_read_b64_tr_b16 v[124:125], v160 offset:4096
  ds_read_b64_tr_b16 v[126:127], v160 offset:5120
  ds_read_b128 v[96:99], v148 offset:0
  ds_read_b128 v[100:103], v148 offset:4096
  s_waitcnt lgkmcnt(12)
  v_mfma_f32_32x32x16_bf16 v[16:31], v[104:107], v[80:83], v[16:31]
  v_mfma_f32_32x32x16_bf16 v[32:47], v[108:111], v[80:83], v[32:47]
  v_mfma_f32_32x32x16_bf16 v[48:63], v[104:107], v[84:87], v[48:63]
  v_mfma_f32_32x32x16_bf16 v[64:79], v[108:111], v[84:87], v[64:79]
  s_barrier
  ds_read_b64_tr_b16 v[104:105], v159 offset:8192
  ds_read_b64_tr_b16 v[106:107], v159 offset:9216
  ds_read_b64_tr_b16 v[108:109], v160 offset:8192
  ds_read_b64_tr_b16 v[110:111], v160 offset:9216
  ds_read_b128 v[80:83], v149 offset:0
  ds_read_b128 v[84:87], v149 offset:4096
  s_waitcnt lgkmcnt(12)
  v_mfma_f32_32x32x16_bf16 v[16:31], v[112:115], v[88:91], v[16:31]
  v_mfma_f32_32x32x16_bf16 v[32:47], v[116:119], v[88:91], v[32:47]
  v_mfma_f32_32x32x16_bf16 v[48:63], v[112:115], v[92:95], v[48:63]
  v_mfma_f32_32x32x16_bf16 v[64:79], v[116:119], v[92:95], v[64:79]
  ds_read_b64_tr_b16 v[112:113], v159 offset:12288
  ds_read_b64_tr_b16 v[114:115], v159 offset:13312
  ds_read_b64_tr_b16 v[116:117], v160 offset:12288
  ds_read_b64_tr_b16 v[118:119], v160 offset:13312
  ds_read_b128 v[88:91], v150 offset:0
  ds_read_b128 v[92:95], v150 offset:4096
  s_waitcnt lgkmcnt(12)
  v_mfma_f32_32x32x16_bf16 v[16:31], v[120:123], v[96:99], v[16:31]
  v_mfma_f32_32x32x16_bf16 v[32:47], v[124:127], v[96:99], v[32:47]
  v_mfma_f32_32x32x16_bf16 v[48:63], v[120:123], v[100:103], v[48:63]
  v_mfma_f32_32x32x16_bf16 v[64:79], v[124:127], v[100:103], v[64:79]
  ds_read_b64_tr_b16 v[120:121], v151 offset:0
  ds_read_b64_tr_b16 v[122:123], v151 offset:1024
  ds_read_b64_tr_b16 v[124:125], v152 offset:0
  ds_read_b64_tr_b16 v[126:127], v152 offset:1024
  ds_read_b128 v[96:99], v131 offset:0
  ds_read_b128 v[100:103], v131 offset:4096
  s_waitcnt lgkmcnt(12)
  v_mfma_f32_32x32x16_bf16 v[16:31], v[104:107], v[80:83], v[16:31]
  v_mfma_f32_32x32x16_bf16 v[32:47], v[108:111], v[80:83], v[32:47]
  v_mfma_f32_32x32x16_bf16 v[48:63], v[104:107], v[84:87], v[48:63]
  v_mfma_f32_32x32x16_bf16 v[64:79], v[108:111], v[84:87], v[64:79]
  ds_read_b64_tr_b16 v[104:105], v151 offset:4096
  ds_read_b64_tr_b16 v[106:107], v151 offset:5120
  ds_read_b64_tr_b16 v[108:109], v152 offset:4096
  ds_read_b64_tr_b16 v[110:111], v152 offset:5120
  ds_read_b128 v[80:83], v132 offset:0
  ds_read_b128 v[84:87], v132 offset:4096
  s_waitcnt lgkmcnt(12)
  v_mfma_f32_32x32x16_bf16 v[16:31], v[112:115], v[88:91], v[16:31]
  v_mfma_f32_32x32x16_bf16 v[32:47], v[116:119], v[88:91], v[32:47]
  v_mfma_f32_32x32x16_bf16 v[48:63], v[112:115], v[92:95], v[48:63]
  v_mfma_f32_32x32x16_bf16 v[64:79], v[116:119], v[92:95], v[64:79]
  s_barrier
  ds_read_b64_tr_b16 v[112:113], v151 offset:8192
  ds_read_b64_tr_b16 v[114:115], v151 offset:9216
  ds_read_b64_tr_b16 v[116:117], v152 offset:8192
  ds_read_b64_tr_b16 v[118:119], v152 offset:9216
  ds_read_b128 v[88:91], v133 offset:0
  ds_read_b128 v[92:95], v133 offset:4096
  s_waitcnt lgkmcnt(12)
  v_mfma_f32_32x32x16_bf16 v[16:31], v[120:123], v[96:99], v[16:31]
  v_mfma_f32_32x32x16_bf16 v[32:47], v[124:127], v[96:99], v[32:47]
  v_mfma_f32_32x32x16_bf16 v[48:63], v[120:123], v[100:103], v[48:63]
  v_mfma_f32_32x32x16_bf16 v[64:79], v[124:127], v[100:103], v[64:79]
  ds_read_b64_tr_b16 v[120:121], v151 offset:12288
  ds_read_b64_tr_b16 v[122:123], v151 offset:13312
  ds_read_b64_tr_b16 v[124:125], v152 offset:12288
  ds_read_b64_tr_b16 v[126:127], v152 offset:13312
  ds_read_b128 v[96:99], v134 offset:0
  ds_read_b128 v[100:103], v134 offset:4096
  s_waitcnt lgkmcnt(12)
  v_mfma_f32_32x32x16_bf16 v[16:31], v[104:107], v[80:83], v[16:31]
  v_mfma_f32_32x32x16_bf16 v[32:47], v[108:111], v[80:83], v[32:47]
  v_mfma_f32_32x32x16_bf16 v[48:63], v[104:107], v[84:87], v[48:63]
  v_mfma_f32_32x32x16_bf16 v[64:79], v[108:111], v[84:87], v[64:79]
  ds_read_b64_tr_b16 v[104:105], v153 offset:0
  ds_read_b64_tr_b16 v[106:107], v153 offset:1024
  ds_read_b64_tr_b16 v[108:109], v154 offset:0
  ds_read_b64_tr_b16 v[110:111], v154 offset:1024
  ds_read_b128 v[80:83], v135 offset:0
  ds_read_b128 v[84:87], v135 offset:4096
  s_waitcnt lgkmcnt(12)
  v_mfma_f32_32x32x16_bf16 v[16:31], v[112:115], v[88:91], v[16:31]
  v_mfma_f32_32x32x16_bf16 v[32:47], v[116:119], v[88:91], v[32:47]
  v_mfma_f32_32x32x16_bf16 v[48:63], v[112:115], v[92:95], v[48:63]
  v_mfma_f32_32x32x16_bf16 v[64:79], v[116:119], v[92:95], v[64:79]
  ds_read_b64_tr_b16 v[112:113], v153 offset:4096
  ds_read_b64_tr_b16 v[114:115], v153 offset:5120
  ds_read_b64_tr_b16 v[116:117], v154 offset:4096
  ds_read_b64_tr_b16 v[118:119], v154 offset:5120
  ds_read_b128 v[88:91], v136 offset:0
  ds_read_b128 v[92:95], v136 offset:4096
  s_waitcnt lgkmcnt(12)
  v_mfma_f32_32x32x16_bf16 v[16:31], v[120:123], v[96:99], v[16:31]
  v_mfma_f32_32x32x16_bf16 v[32:47], v[124:127], v[96:99], v[32:47]
  v_mfma_f32_32x32x16_bf16 v[48:63], v[120:123], v[100:103], v[48:63]
  v_mfma_f32_32x32x16_bf16 v[64:79], v[124:127], v[100:103], v[64:79]
  s_barrier
  ds_read_b64_tr_b16 v[120:121], v153 offset:8192
  ds_read_b64_tr_b16 v[122:123], v153 offset:9216
  ds_read_b64_tr_b16 v[124:125], v154 offset:8192
  ds_read_b64_tr_b16 v[126:127], v154 offset:9216
  ds_read_b128 v[96:99], v137 offset:0
  ds_read_b128 v[100:103], v137 offset:4096
  s_waitcnt lgkmcnt(12)
  v_mfma_f32_32x32x16_bf16 v[16:31], v[104:107], v[80:83], v[16:31]
  v_mfma_f32_32x32x16_bf16 v[32:47], v[108:111], v[80:83], v[32:47]
  v_mfma_f32_32x32x16_bf16 v[48:63], v[104:107], v[84:87], v[48:63]
  v_mfma_f32_32x32x16_bf16 v[64:79], v[108:111], v[84:87], v[64:79]
  ds_read_b64_tr_b16 v[104:105], v153 offset:12288
  ds_read_b64_tr_b16 v[106:107], v153 offset:13312
  ds_read_b64_tr_b16 v[108:109], v154 offset:12288
  ds_read_b64_tr_b16 v[110:111], v154 offset:13312
  ds_read_b128 v[80:83], v138 offset:0
  ds_read_b128 v[84:87], v138 offset:4096
  s_waitcnt lgkmcnt(12)
  v_mfma_f32_32x32x16_bf16 v[16:31], v[112:115], v[88:91], v[16:31]
  v_mfma_f32_32x32x16_bf16 v[32:47], v[116:119], v[88:91], v[32:47]
  v_mfma_f32_32x32x16_bf16 v[48:63], v[112:115], v[92:95], v[48:63]
  v_mfma_f32_32x32x16_bf16 v[64:79], v[116:119], v[92:95], v[64:79]
  s_waitcnt lgkmcnt(6)
  v_mfma_f32_32x32x16_bf16 v[16:31], v[120:123], v[96:99], v[16:31]
  v_mfma_f32_32x32x16_bf16 v[32:47], v[124:127], v[96:99], v[32:47]
  v_mfma_f32_32x32x16_bf16 v[48:63], v[120:123], v[100:103], v[48:63]
  v_mfma_f32_32x32x16_bf16 v[64:79], v[124:127], v[100:103], v[64:79]
  s_waitcnt lgkmcnt(0)
  v_mfma_f32_32x32x16_bf16 v[16:31], v[104:107], v[80:83], v[16:31]
  v_mfma_f32_32x32x16_bf16 v[32:47], v[108:111], v[80:83], v[32:47]
  v_mfma_f32_32x32x16_bf16 v[48:63], v[104:107], v[84:87], v[48:63]
  v_mfma_f32_32x32x16_bf16 v[64:79], v[108:111], v[84:87], v[64:79]
  s_barrier
  s_nop 11
  ds_write_b128 v129, v[16:19] offset:0
  ds_write_b128 v129, v[20:23] offset:32
  ds_write_b128 v129, v[24:27] offset:64
  ds_write_b128 v129, v[28:31] offset:96
  ds_write_b128 v129, v[32:35] offset:128
  ds_write_b128 v129, v[36:39] offset:160
  ds_write_b128 v129, v[40:43] offset:192
  ds_write_b128 v129, v[44:47] offset:224
  ds_write_b128 v129, v[48:51] offset:16896
  ds_write_b128 v129, v[52:55] offset:16928
  ds_write_b128 v129, v[56:59] offset:16960
  ds_write_b128 v129, v[60:63] offset:16992
  ds_write_b128 v129, v[64:67] offset:17024
  ds_write_b128 v129, v[68:71] offset:17056
  ds_write_b128 v129, v[72:75] offset:17088
  ds_write_b128 v129, v[76:79] offset:17120
gemm1_kernel_epi:
  s_waitcnt lgkmcnt(0)
  s_barrier
  ds_read_b128 v[12:15], v8 offset:0
  ds_read_b128 v[16:19], v8 offset:16
  ds_read_b128 v[20:23], v8 offset:16896
  ds_read_b128 v[24:27], v8 offset:16912
  ds_read_b128 v[28:31], v8 offset:33792
  ds_read_b128 v[32:35], v8 offset:33808
  ds_read_b128 v[36:39], v8 offset:50688
  ds_read_b128 v[40:43], v8 offset:50704
  v_mov_b32 v44, 0xc0135761
  v_mov_b32 v46, 0xbdd2d3e8
  v_mov_b32 v45, 0xc0135761
  v_mov_b32 v47, 0xbdd2d3e8
  s_waitcnt lgkmcnt(0)
  v_cvt_pk_bf16_f32 v64, v12, v13
  v_cvt_pk_bf16_f32 v65, v14, v15
  v_cvt_pk_bf16_f32 v66, v16, v17
  v_cvt_pk_bf16_f32 v67, v18, v19
  v_cvt_pk_bf16_f32 v68, v20, v21
  v_cvt_pk_bf16_f32 v69, v22, v23
  v_cvt_pk_bf16_f32 v70, v24, v25
  v_cvt_pk_bf16_f32 v71, v26, v27
  v_lshlrev_b32 v12, 16, v64
  v_and_b32 v13, 0xffff0000, v64
  v_lshlrev_b32 v14, 16, v65
  v_and_b32 v15, 0xffff0000, v65
  v_lshlrev_b32 v16, 16, v66
  v_and_b32 v17, 0xffff0000, v66
  v_lshlrev_b32 v18, 16, v67
  v_and_b32 v19, 0xffff0000, v67
  v_lshlrev_b32 v20, 16, v68
  v_and_b32 v21, 0xffff0000, v68
  v_lshlrev_b32 v22, 16, v69
  v_and_b32 v23, 0xffff0000, v69
  v_lshlrev_b32 v24, 16, v70
  v_and_b32 v25, 0xffff0000, v70
  v_lshlrev_b32 v26, 16, v71
  v_and_b32 v27, 0xffff0000, v71
  v_pk_mul_f32 v[48:49], v[12:13], v[12:13]
  v_pk_mul_f32 v[50:51], v[14:15], v[14:15]
  v_pk_mul_f32 v[52:53], v[16:17], v[16:17]
  v_pk_mul_f32 v[54:55], v[18:19], v[18:19]
  v_pk_mul_f32 v[56:57], v[20:21], v[20:21]
  v_pk_mul_f32 v[58:59], v[22:23], v[22:23]
  v_pk_mul_f32 v[60:61], v[24:25], v[24:25]
  v_pk_mul_f32 v[62:63], v[26:27], v[26:27]
  v_pk_fma_f32 v[48:49], v[48:49], v[46:47], v[44:45]
  v_pk_fma_f32 v[50:51], v[50:51], v[46:47], v[44:45]
  v_pk_fma_f32 v[52:53], v[52:53], v[46:47], v[44:45]
  v_pk_fma_f32 v[54:55], v[54:55], v[46:47], v[44:45]
  v_pk_fma_f32 v[56:57], v[56:57], v[46:47], v[44:45]
  v_pk_fma_f32 v[58:59], v[58:59], v[46:47], v[44:45]
  v_pk_fma_f32 v[60:61], v[60:61], v[46:47], v[44:45]
  v_pk_fma_f32 v[62:63], v[62:63], v[46:47], v[44:45]
  v_pk_mul_f32 v[48:49], v[48:49], v[12:13]
  v_pk_mul_f32 v[50:51], v[50:51], v[14:15]
  v_pk_mul_f32 v[52:53], v[52:53], v[16:17]
  v_pk_mul_f32 v[54:55], v[54:55], v[18:19]
  v_pk_mul_f32 v[56:57], v[56:57], v[20:21]
  v_pk_mul_f32 v[58:59], v[58:59], v[22:23]
  v_pk_mul_f32 v[60:61], v[60:61], v[24:25]
  v_pk_mul_f32 v[62:63], v[62:63], v[26:27]
  v_exp_f32 v48, v48
  v_exp_f32 v49, v49
  v_exp_f32 v50, v50
  v_exp_f32 v51, v51
  v_exp_f32 v52, v52
  v_exp_f32 v53, v53
  v_exp_f32 v54, v54
  v_exp_f32 v55, v55
  v_exp_f32 v56, v56
  v_exp_f32 v57, v57
  v_exp_f32 v58, v58
  v_exp_f32 v59, v59
  v_exp_f32 v60, v60
  v_exp_f32 v61, v61
  v_exp_f32 v62, v62
  v_exp_f32 v63, v63
  v_add_f32 v48, 1.0, v48
  v_add_f32 v49, 1.0, v49
  v_add_f32 v50, 1.0, v50
  v_add_f32 v51, 1.0, v51
  v_add_f32 v52, 1.0, v52
  v_add_f32 v53, 1.0, v53
  v_add_f32 v54, 1.0, v54
  v_add_f32 v55, 1.0, v55
  v_add_f32 v56, 1.0, v56
  v_add_f32 v57, 1.0, v57
  v_add_f32 v58, 1.0, v58
  v_add_f32 v59, 1.0, v59
  v_add_f32 v60, 1.0, v60
  v_add_f32 v61, 1.0, v61
  v_add_f32 v62, 1.0, v62
  v_add_f32 v63, 1.0, v63
  v_rcp_f32 v48, v48
  v_rcp_f32 v49, v49
  v_rcp_f32 v50, v50
  v_rcp_f32 v51, v51
  v_rcp_f32 v52, v52
  v_rcp_f32 v53, v53
  v_rcp_f32 v54, v54
  v_rcp_f32 v55, v55
  v_rcp_f32 v56, v56
  v_rcp_f32 v57, v57
  v_rcp_f32 v58, v58
  v_rcp_f32 v59, v59
  v_rcp_f32 v60, v60
  v_rcp_f32 v61, v61
  v_rcp_f32 v62, v62
  v_rcp_f32 v63, v63
  v_pk_mul_f32 v[48:49], v[48:49], v[12:13]
  v_pk_mul_f32 v[50:51], v[50:51], v[14:15]
  v_pk_mul_f32 v[52:53], v[52:53], v[16:17]
  v_pk_mul_f32 v[54:55], v[54:55], v[18:19]
  v_pk_mul_f32 v[56:57], v[56:57], v[20:21]
  v_pk_mul_f32 v[58:59], v[58:59], v[22:23]
  v_pk_mul_f32 v[60:61], v[60:61], v[24:25]
  v_pk_mul_f32 v[62:63], v[62:63], v[26:27]
  v_cvt_pk_bf16_f32 v64, v48, v49
  v_cvt_pk_bf16_f32 v65, v50, v51
  v_cvt_pk_bf16_f32 v66, v52, v53
  v_cvt_pk_bf16_f32 v67, v54, v55
  v_cvt_pk_bf16_f32 v68, v56, v57
  v_cvt_pk_bf16_f32 v69, v58, v59
  v_cvt_pk_bf16_f32 v70, v60, v61
  v_cvt_pk_bf16_f32 v71, v62, v63
  s_mov_b32 s56, 0
  buffer_store_dwordx4 v[64:67], v9, s[16:19], s56 offen sc1
  s_mov_b32 s56, 114688
  buffer_store_dwordx4 v[68:71], v9, s[16:19], s56 offen sc1
  v_cvt_pk_bf16_f32 v72, v28, v29
  v_cvt_pk_bf16_f32 v73, v30, v31
  v_cvt_pk_bf16_f32 v74, v32, v33
  v_cvt_pk_bf16_f32 v75, v34, v35
  v_cvt_pk_bf16_f32 v76, v36, v37
  v_cvt_pk_bf16_f32 v77, v38, v39
  v_cvt_pk_bf16_f32 v78, v40, v41
  v_cvt_pk_bf16_f32 v79, v42, v43
  v_lshlrev_b32 v28, 16, v72
  v_and_b32 v29, 0xffff0000, v72
  v_lshlrev_b32 v30, 16, v73
  v_and_b32 v31, 0xffff0000, v73
  v_lshlrev_b32 v32, 16, v74
  v_and_b32 v33, 0xffff0000, v74
  v_lshlrev_b32 v34, 16, v75
  v_and_b32 v35, 0xffff0000, v75
  v_lshlrev_b32 v36, 16, v76
  v_and_b32 v37, 0xffff0000, v76
  v_lshlrev_b32 v38, 16, v77
  v_and_b32 v39, 0xffff0000, v77
  v_lshlrev_b32 v40, 16, v78
  v_and_b32 v41, 0xffff0000, v78
  v_lshlrev_b32 v42, 16, v79
  v_and_b32 v43, 0xffff0000, v79
  v_pk_mul_f32 v[48:49], v[28:29], v[28:29]
  v_pk_mul_f32 v[50:51], v[30:31], v[30:31]
  v_pk_mul_f32 v[52:53], v[32:33], v[32:33]
  v_pk_mul_f32 v[54:55], v[34:35], v[34:35]
  v_pk_mul_f32 v[56:57], v[36:37], v[36:37]
  v_pk_mul_f32 v[58:59], v[38:39], v[38:39]
  v_pk_mul_f32 v[60:61], v[40:41], v[40:41]
  v_pk_mul_f32 v[62:63], v[42:43], v[42:43]
  v_pk_fma_f32 v[48:49], v[48:49], v[46:47], v[44:45]
  v_pk_fma_f32 v[50:51], v[50:51], v[46:47], v[44:45]
  v_pk_fma_f32 v[52:53], v[52:53], v[46:47], v[44:45]
  v_pk_fma_f32 v[54:55], v[54:55], v[46:47], v[44:45]
  v_pk_fma_f32 v[56:57], v[56:57], v[46:47], v[44:45]
  v_pk_fma_f32 v[58:59], v[58:59], v[46:47], v[44:45]
  v_pk_fma_f32 v[60:61], v[60:61], v[46:47], v[44:45]
  v_pk_fma_f32 v[62:63], v[62:63], v[46:47], v[44:45]
  v_pk_mul_f32 v[48:49], v[48:49], v[28:29]
  v_pk_mul_f32 v[50:51], v[50:51], v[30:31]
  v_pk_mul_f32 v[52:53], v[52:53], v[32:33]
  v_pk_mul_f32 v[54:55], v[54:55], v[34:35]
  v_pk_mul_f32 v[56:57], v[56:57], v[36:37]
  v_pk_mul_f32 v[58:59], v[58:59], v[38:39]
  v_pk_mul_f32 v[60:61], v[60:61], v[40:41]
  v_pk_mul_f32 v[62:63], v[62:63], v[42:43]
  v_exp_f32 v48, v48
  v_exp_f32 v49, v49
  v_exp_f32 v50, v50
  v_exp_f32 v51, v51
  v_exp_f32 v52, v52
  v_exp_f32 v53, v53
  v_exp_f32 v54, v54
  v_exp_f32 v55, v55
  v_exp_f32 v56, v56
  v_exp_f32 v57, v57
  v_exp_f32 v58, v58
  v_exp_f32 v59, v59
  v_exp_f32 v60, v60
  v_exp_f32 v61, v61
  v_exp_f32 v62, v62
  v_exp_f32 v63, v63
  v_add_f32 v48, 1.0, v48
  v_add_f32 v49, 1.0, v49
  v_add_f32 v50, 1.0, v50
  v_add_f32 v51, 1.0, v51
  v_add_f32 v52, 1.0, v52
  v_add_f32 v53, 1.0, v53
  v_add_f32 v54, 1.0, v54
  v_add_f32 v55, 1.0, v55
  v_add_f32 v56, 1.0, v56
  v_add_f32 v57, 1.0, v57
  v_add_f32 v58, 1.0, v58
  v_add_f32 v59, 1.0, v59
  v_add_f32 v60, 1.0, v60
  v_add_f32 v61, 1.0, v61
  v_add_f32 v62, 1.0, v62
  v_add_f32 v63, 1.0, v63
  v_rcp_f32 v48, v48
  v_rcp_f32 v49, v49
  v_rcp_f32 v50, v50
  v_rcp_f32 v51, v51
  v_rcp_f32 v52, v52
  v_rcp_f32 v53, v53
  v_rcp_f32 v54, v54
  v_rcp_f32 v55, v55
  v_rcp_f32 v56, v56
  v_rcp_f32 v57, v57
  v_rcp_f32 v58, v58
  v_rcp_f32 v59, v59
  v_rcp_f32 v60, v60
  v_rcp_f32 v61, v61
  v_rcp_f32 v62, v62
  v_rcp_f32 v63, v63
  v_pk_mul_f32 v[48:49], v[48:49], v[28:29]
  v_pk_mul_f32 v[50:51], v[50:51], v[30:31]
  v_pk_mul_f32 v[52:53], v[52:53], v[32:33]
  v_pk_mul_f32 v[54:55], v[54:55], v[34:35]
  v_pk_mul_f32 v[56:57], v[56:57], v[36:37]
  v_pk_mul_f32 v[58:59], v[58:59], v[38:39]
  v_pk_mul_f32 v[60:61], v[60:61], v[40:41]
  v_pk_mul_f32 v[62:63], v[62:63], v[42:43]
  v_cvt_pk_bf16_f32 v72, v48, v49
  v_cvt_pk_bf16_f32 v73, v50, v51
  v_cvt_pk_bf16_f32 v74, v52, v53
  v_cvt_pk_bf16_f32 v75, v54, v55
  v_cvt_pk_bf16_f32 v76, v56, v57
  v_cvt_pk_bf16_f32 v77, v58, v59
  v_cvt_pk_bf16_f32 v78, v60, v61
  v_cvt_pk_bf16_f32 v79, v62, v63
  s_mov_b32 s56, 229376
  buffer_store_dwordx4 v[72:75], v9, s[16:19], s56 offen sc1
  s_mov_b32 s56, 344064
  buffer_store_dwordx4 v[76:79], v9, s[16:19], s56 offen sc1
  s_cmp_lt_u32 s49, 7
  s_cbranch_scc1 gemm1_kernel_nostats
  v_lshlrev_b32 v12, 16, v64
  v_and_b32 v13, 0xffff0000, v64
  v_lshlrev_b32 v14, 16, v65
  v_and_b32 v15, 0xffff0000, v65
  v_lshlrev_b32 v16, 16, v66
  v_and_b32 v17, 0xffff0000, v66
  v_lshlrev_b32 v18, 16, v67
  v_and_b32 v19, 0xffff0000, v67
  v_lshlrev_b32 v20, 16, v68
  v_and_b32 v21, 0xffff0000, v68
  v_lshlrev_b32 v22, 16, v69
  v_and_b32 v23, 0xffff0000, v69
  v_lshlrev_b32 v24, 16, v70
  v_and_b32 v25, 0xffff0000, v70
  v_lshlrev_b32 v26, 16, v71
  v_and_b32 v27, 0xffff0000, v71
  v_lshlrev_b32 v28, 16, v72
  v_and_b32 v29, 0xffff0000, v72
  v_lshlrev_b32 v30, 16, v73
  v_and_b32 v31, 0xffff0000, v73
  v_lshlrev_b32 v32, 16, v74
  v_and_b32 v33, 0xffff0000, v74
  v_lshlrev_b32 v34, 16, v75
  v_and_b32 v35, 0xffff0000, v75
  v_lshlrev_b32 v36, 16, v76
  v_and_b32 v37, 0xffff0000, v76
  v_lshlrev_b32 v38, 16, v77
  v_and_b32 v39, 0xffff0000, v77
  v_lshlrev_b32 v40, 16, v78
  v_and_b32 v41, 0xffff0000, v78
  v_lshlrev_b32 v42, 16, v79
  v_and_b32 v43, 0xffff0000, v79
  v_pk_add_f32 v[80:81], v[12:13], v[14:15]
  v_pk_add_f32 v[82:83], v[20:21], v[22:23]
  v_pk_add_f32 v[84:85], v[28:29], v[30:31]
  v_pk_add_f32 v[86:87], v[36:37], v[38:39]
  v_pk_add_f32 v[80:81], v[80:81], v[16:17]
  v_pk_add_f32 v[82:83], v[82:83], v[24:25]
  v_pk_add_f32 v[84:85], v[84:85], v[32:33]
  v_pk_add_f32 v[86:87], v[86:87], v[40:41]
  v_pk_add_f32 v[80:81], v[80:81], v[18:19]
  v_pk_add_f32 v[82:83], v[82:83], v[26:27]
  v_pk_add_f32 v[84:85], v[84:85], v[34:35]
  v_pk_add_f32 v[86:87], v[86:87], v[42:43]
  v_add_f32 v96, v80, v81
  v_add_f32 v98, v82, v83
  v_add_f32 v100, v84, v85
  v_add_f32 v102, v86, v87
  s_nop 1
  v_add_f32_dpp v96, v96, v96 quad_perm:[1,0,3,2] row_mask:0xf bank_mask:0xf
  v_add_f32_dpp v98, v98, v98 quad_perm:[1,0,3,2] row_mask:0xf bank_mask:0xf
  v_add_f32_dpp v100, v100, v100 quad_perm:[1,0,3,2] row_mask:0xf bank_mask:0xf
  v_add_f32_dpp v102, v102, v102 quad_perm:[1,0,3,2] row_mask:0xf bank_mask:0xf
  s_nop 1
  v_add_f32_dpp v96, v96, v96 quad_perm:[2,3,0,1] row_mask:0xf bank_mask:0xf
  v_add_f32_dpp v98, v98, v98 quad_perm:[2,3,0,1] row_mask:0xf bank_mask:0xf
  v_add_f32_dpp v100, v100, v100 quad_perm:[2,3,0,1] row_mask:0xf bank_mask:0xf
  v_add_f32_dpp v102, v102, v102 quad_perm:[2,3,0,1] row_mask:0xf bank_mask:0xf
  s_nop 1
  v_add_f32_dpp v96, v96, v96 row_half_mirror row_mask:0xf bank_mask:0xf
  v_add_f32_dpp v98, v98, v98 row_half_mirror row_mask:0xf bank_mask:0xf
  v_add_f32_dpp v100, v100, v100 row_half_mirror row_mask:0xf bank_mask:0xf
  v_add_f32_dpp v102, v102, v102 row_half_mirror row_mask:0xf bank_mask:0xf
  s_nop 1
  v_add_f32_dpp v96, v96, v96 row_mirror row_mask:0xf bank_mask:0xf
  v_add_f32_dpp v98, v98, v98 row_mirror row_mask:0xf bank_mask:0xf
  v_add_f32_dpp v100, v100, v100 row_mirror row_mask:0xf bank_mask:0xf
  v_add_f32_dpp v102, v102, v102 row_mirror row_mask:0xf bank_mask:0xf
  v_mul_f32 v96, 0x3c000000, v96
  v_mul_f32 v98, 0x3c000000, v98
  v_mul_f32 v100, 0x3c000000, v100
  v_mul_f32 v102, 0x3c000000, v102
  v_sub_f32 v88, 0, v96
  v_sub_f32 v89, 0, v96
  v_sub_f32 v90, 0, v98
  v_sub_f32 v91, 0, v98
  v_sub_f32 v92, 0, v100
  v_sub_f32 v93, 0, v100
  v_sub_f32 v94, 0, v102
  v_sub_f32 v95, 0, v102
  v_pk_add_f32 v[12:13], v[12:13], v[88:89]
  v_pk_add_f32 v[20:21], v[20:21], v[90:91]
  v_pk_add_f32 v[28:29], v[28:29], v[92:93]
  v_pk_add_f32 v[36:37], v[36:37], v[94:95]
  v_pk_add_f32 v[14:15], v[14:15], v[88:89]
  v_pk_add_f32 v[22:23], v[22:23], v[90:91]
  v_pk_add_f32 v[30:31], v[30:31], v[92:93]
  v_pk_add_f32 v[38:39], v[38:39], v[94:95]
  v_pk_add_f32 v[16:17], v[16:17], v[88:89]
  v_pk_add_f32 v[24:25], v[24:25], v[90:91]
  v_pk_add_f32 v[32:33], v[32:33], v[92:93]
  v_pk_add_f32 v[40:41], v[40:41], v[94:95]
  v_pk_add_f32 v[18:19], v[18:19], v[88:89]
  v_pk_add_f32 v[26:27], v[26:27], v[90:91]
  v_pk_add_f32 v[34:35], v[34:35], v[92:93]
  v_pk_add_f32 v[42:43], v[42:43], v[94:95]
  v_pk_mul_f32 v[80:81], v[12:13], v[12:13]
  v_pk_mul_f32 v[82:83], v[20:21], v[20:21]
  v_pk_mul_f32 v[84:85], v[28:29], v[28:29]
  v_pk_mul_f32 v[86:87], v[36:37], v[36:37]
  v_pk_fma_f32 v[80:81], v[14:15], v[14:15], v[80:81]
  v_pk_fma_f32 v[82:83], v[22:23], v[22:23], v[82:83]
  v_pk_fma_f32 v[84:85], v[30:31], v[30:31], v[84:85]
  v_pk_fma_f32 v[86:87], v[38:39], v[38:39], v[86:87]
  v_pk_fma_f32 v[80:81], v[16:17], v[16:17], v[80:81]
  v_pk_fma_f32 v[82:83], v[24:25], v[24:25], v[82:83]
  v_pk_fma_f32 v[84:85], v[32:33], v[32:33], v[84:85]
  v_pk_fma_f32 v[86:87], v[40:41], v[40:41], v[86:87]
  v_pk_fma_f32 v[80:81], v[18:19], v[18:19], v[80:81]
  v_pk_fma_f32 v[82:83], v[26:27], v[26:27], v[82:83]
  v_pk_fma_f32 v[84:85], v[34:35], v[34:35], v[84:85]
  v_pk_fma_f32 v[86:87], v[42:43], v[42:43], v[86:87]
  v_add_f32 v97, v80, v81
  v_add_f32 v99, v82, v83
  v_add_f32 v101, v84, v85
  v_add_f32 v103, v86, v87
  s_nop 1
  v_add_f32_dpp v97, v97, v97 quad_perm:[1,0,3,2] row_mask:0xf bank_mask:0xf
  v_add_f32_dpp v99, v99, v99 quad_perm:[1,0,3,2] row_mask:0xf bank_mask:0xf
  v_add_f32_dpp v101, v101, v101 quad_perm:[1,0,3,2] row_mask:0xf bank_mask:0xf
  v_add_f32_dpp v103, v103, v103 quad_perm:[1,0,3,2] row_mask:0xf bank_mask:0xf
  s_nop 1
  v_add_f32_dpp v97, v97, v97 quad_perm:[2,3,0,1] row_mask:0xf bank_mask:0xf
  v_add_f32_dpp v99, v99, v99 quad_perm:[2,3,0,1] row_mask:0xf bank_mask:0xf
  v_add_f32_dpp v101, v101, v101 quad_perm:[2,3,0,1] row_mask:0xf bank_mask:0xf
  v_add_f32_dpp v103, v103, v103 quad_perm:[2,3,0,1] row_mask:0xf bank_mask:0xf
  s_nop 1
  v_add_f32_dpp v97, v97, v97 row_half_mirror row_mask:0xf bank_mask:0xf
  v_add_f32_dpp v99, v99, v99 row_half_mirror row_mask:0xf bank_mask:0xf
  v_add_f32_dpp v101, v101, v101 row_half_mirror row_mask:0xf bank_mask:0xf
  v_add_f32_dpp v103, v103, v103 row_half_mirror row_mask:0xf bank_mask:0xf
  s_nop 1
  v_add_f32_dpp v97, v97, v97 row_mirror row_mask:0xf bank_mask:0xf
  v_add_f32_dpp v99, v99, v99 row_mirror row_mask:0xf bank_mask:0xf
  v_add_f32_dpp v101, v101, v101 row_mirror row_mask:0xf bank_mask:0xf
  v_add_f32_dpp v103, v103, v103 row_mirror row_mask:0xf bank_mask:0xf
  v_and_b32 v104, 15, v0
  v_cmp_eq_u32 vcc, 0, v104
  s_and_saveexec_b64 s[60:61], vcc
  buffer_store_dwordx2 v[96:97], v10, s[24:27], 0 offen offset:0
  buffer_store_dwordx2 v[98:99], v10, s[24:27], 0 offen offset:256
  buffer_store_dwordx2 v[100:101], v10, s[24:27], 0 offen offset:512
  buffer_store_dwordx2 v[102:103], v10, s[24:27], 0 offen offset:768
  s_mov_b64 exec, s[60:61]
gemm1_kernel_nostats:
gemm1_kernel_end:
  s_endpgm
gemm1_kernel_pf:
  s_load_dwordx16 s[32:47], s[0:1], 0
  s_lshl_b32 s51, s2, 15
  s_mul_i32 s52, s2, 3136
  v_lshlrev_b32 v1, 4, v0
  s_waitcnt lgkmcnt(0)
  s_mov_b32 s8, s36
  s_mov_b32 s9, s37
  s_and_b32 s9, s9, 0xffff
  s_mov_b32 s10, 0x800000
  s_mov_b32 s11, 0x20000
  s_mov_b32 s12, s40
  s_mov_b32 s13, s41
  s_and_b32 s13, s13, 0xffff
  s_mov_b32 s14, 0xc4000
  s_mov_b32 s15, 0x20000
  buffer_load_dwordx4 v[68:71], v1, s[12:15], s52 offen
  buffer_load_dwordx4 v[4:7], v1, s[8:11], s51 offen
  s_add_u32 s51, s51, 8192
  buffer_load_dwordx4 v[8:11], v1, s[8:11], s51 offen
  s_add_u32 s51, s51, 8192
  buffer_load_dwordx4 v[12:15], v1, s[8:11], s51 offen
  s_add_u32 s51, s51, 8192
  buffer_load_dwordx4 v[16:19], v1, s[8:11], s51 offen
  s_add_u32 s51, s51, 8192
  s_endpgm
.globl gemm2_kernel
.p2align 8
.type gemm2_kernel,@function
gemm2_kernel:
  s_cmp_ge_u32 s2, 224
  s_cbranch_scc1 gemm2_kernel_end
  s_load_dwordx16 s[32:47], s[0:1], 0
  s_and_b32 s56, s2, 7
  s_lshr_b32 s57, s2, 3
  s_and_b32 s48, s57, 3
  s_lshr_b32 s49, s57, 2
  s_lshr_b32 s58, s56, 1
  s_lshl_b32 s58, s58, 2
  s_add_u32 s48, s48, s58
  s_and_b32 s58, s56, 1
  s_mul_i32 s58, s58, 7
  s_add_u32 s49, s49, s58
  v_and_b32 v1, 63, v0
  v_lshrrev_b32 v2, 6, v0
  s_nop 0
  v_readfirstlane_b32 s50, v2
  v_and_b32 v2, 3, v2
  s_mov_b32 s59, s50
  s_cmp_lt_u32 s50, 4
  s_cbranch_scc1 gemm2_kernel_cons
  s_cmp_lt_u32 s50, 8
  s_cbranch_scc1 gemm2_kernel_bw
  s_sub_u32 s50, s50, 8
  s_mul_i32 s56, s48, 524288
  s_mov_b32 s57, 4096
  v_lshrrev_b32 v3, 3, v1
  v_mul_u32_u24 v4, 64, v2
  v_add3_u32 v3, v3, v4, 0
  v_bfe_u32 v4, v3, 1, 3
  v_and_b32 v5, 7, v1
  v_xor_b32 v5, v5, v4
  v_lshlrev_b32 v5, 4, v5
  v_mul_lo_u32 v3, v3, s57
  v_add3_u32 v20, v3, v5, s56
  v_lshrrev_b32 v3, 3, v1
  v_mul_u32_u24 v4, 64, v2
  v_add3_u32 v3, v3, v4, 8
  v_bfe_u32 v4, v3, 1, 3
  v_and_b32 v5, 7, v1
  v_xor_b32 v5, v5, v4
  v_lshlrev_b32 v5, 4, v5
  v_mul_lo_u32 v3, v3, s57
  v_add3_u32 v21, v3, v5, s56
  v_lshrrev_b32 v3, 3, v1
  v_mul_u32_u24 v4, 64, v2
  v_add3_u32 v3, v3, v4, 16
  v_bfe_u32 v4, v3, 1, 3
  v_and_b32 v5, 7, v1
  v_xor_b32 v5, v5, v4
  v_lshlrev_b32 v5, 4, v5
  v_mul_lo_u32 v3, v3, s57
  v_add3_u32 v22, v3, v5, s56
  v_lshrrev_b32 v3, 3, v1
  v_mul_u32_u24 v4, 64, v2
  v_add3_u32 v3, v3, v4, 24
  v_bfe_u32 v4, v3, 1, 3
  v_and_b32 v5, 7, v1
  v_xor_b32 v5, v5, v4
  v_lshlrev_b32 v5, 4, v5
  v_mul_lo_u32 v3, v3, s57
  v_add3_u32 v23, v3, v5, s56
  v_lshrrev_b32 v3, 3, v1
  v_mul_u32_u24 v4, 64, v2
  v_add3_u32 v3, v3, v4, 32
  v_bfe_u32 v4, v3, 1, 3
  v_and_b32 v5, 7, v1
  v_xor_b32 v5, v5, v4
  v_lshlrev_b32 v5, 4, v5
  v_mul_lo_u32 v3, v3, s57
  v_add3_u32 v24, v3, v5, s56
  v_lshrrev_b32 v3, 3, v1
  v_mul_u32_u24 v4, 64, v2
  v_add3_u32 v3, v3, v4, 40
  v_bfe_u32 v4, v3, 1, 3
  v_and_b32 v5, 7, v1
  v_xor_b32 v5, v5, v4
  v_lshlrev_b32 v5, 4, v5
  v_mul_lo_u32 v3, v3, s57
  v_add3_u32 v25, v3, v5, s56
  v_lshrrev_b32 v3, 3, v1
  v_mul_u32_u24 v4, 64, v2
  v_add3_u32 v3, v3, v4, 48
  v_bfe_u32 v4, v3, 1, 3
  v_and_b32 v5, 7, v1
  v_xor_b32 v5, v5, v4
  v_lshlrev_b32 v5, 4, v5
  v_mul_lo_u32 v3, v3, s57
  v_add3_u32 v26, v3, v5, s56
  v_lshrrev_b32 v3, 3, v1
  v_mul_u32_u24 v4, 64, v2
  v_add3_u32 v3, v3, v4, 56
  v_bfe_u32 v4, v3, 1, 3
  v_and_b32 v5, 7, v1
  v_xor_b32 v5, v5, v4
  v_lshlrev_b32 v5, 4, v5
  v_mul_lo_u32 v3, v3, s57
  v_add3_u32 v27, v3, v5, s56
  s_mul_i32 s53, s50, 8192
  s_mov_b32 s51, 0
  s_waitcnt lgkmcnt(0)
  s_mov_b32 s8, s36
  s_mov_b32 s9, s37
  s_and_b32 s9, s9, 0xffff
  s_mov_b32 s10, 0x800000
  s_mov_b32 s11, 0x20000
  s_add_u32 m0, s53, 0
  s_nop 0
  buffer_load_dwordx4 v20, s[8:11], s51 offen lds
  s_add_u32 m0, s53, 1024
  s_nop 0
  buffer_load_dwordx4 v21, s[8:11], s51 offen lds
  s_add_u32 m0, s53, 2048
  s_nop 0
  buffer_load_dwordx4 v22, s[8:11], s51 offen lds
  s_add_u32 m0, s53, 3072
  s_nop 0
  buffer_load_dwordx4 v23, s[8:11], s51 offen lds
  s_add_u32 m0, s53, 4096
  s_nop 0
  buffer_load_dwordx4 v24, s[8:11], s51 offen lds
  s_add_u32 m0, s53, 5120
  s_nop 0
  buffer_load_dwordx4 v25, s[8:11], s51 offen lds
  s_add_u32 m0, s53, 6144
  s_nop 0
  buffer_load_dwordx4 v26, s[8:11], s51 offen lds
  s_add_u32 m0, s53, 7168
  s_nop 0
  buffer_load_dwordx4 v27, s[8:11], s51 offen lds
  s_add_u32 s51, s51, 128
  s_add_u32 m0, s53, 16384
  s_nop 0
  buffer_load_dwordx4 v20, s[8:11], s51 offen lds
  s_add_u32 m0, s53, 17408
  s_nop 0
  buffer_load_dwordx4 v21, s[8:11], s51 offen lds
  s_add_u32 m0, s53, 18432
  s_nop 0
  buffer_load_dwordx4 v22, s[8:11], s51 offen lds
  s_add_u32 m0, s53, 19456
  s_nop 0
  buffer_load_dwordx4 v23, s[8:11], s51 offen lds
  s_add_u32 m0, s53, 20480
  s_nop 0
  buffer_load_dwordx4 v24, s[8:11], s51 offen lds
  s_add_u32 m0, s53, 21504
  s_nop 0
  buffer_load_dwordx4 v25, s[8:11], s51 offen lds
  s_add_u32 m0, s53, 22528
  s_nop 0
  buffer_load_dwordx4 v26, s[8:11], s51 offen lds
  s_add_u32 m0, s53, 23552
  s_nop 0
  buffer_load_dwordx4 v27, s[8:11], s51 offen lds
  s_add_u32 s51, s51, 128
  s_barrier
  s_add_u32 m0, s53, 32768
  s_nop 0
  buffer_load_dwordx4 v20, s[8:11], s51 offen lds
  s_add_u32 m0, s53, 33792
  s_nop 0
  buffer_load_dwordx4 v21, s[8:11], s51 offen lds
  s_add_u32 m0, s53, 34816
  s_nop 0
  buffer_load_dwordx4 v22, s[8:11], s51 offen lds
  s_add_u32 m0, s53, 35840
  s_nop 0
  buffer_load_dwordx4 v23, s[8:11], s51 offen lds
  s_add_u32 m0, s53, 36864
  s_nop 0
  buffer_load_dwordx4 v24, s[8:11], s51 offen lds
  s_add_u32 m0, s53, 37888
  s_nop 0
  buffer_load_dwordx4 v25, s[8:11], s51 offen lds
  s_add_u32 m0, s53, 38912
  s_nop 0
  buffer_load_dwordx4 v26, s[8:11], s51 offen lds
  s_add_u32 m0, s53, 39936
  s_nop 0
  buffer_load_dwordx4 v27, s[8:11], s51 offen lds
  s_add_u32 s51, s51, 128
  s_add_u32 m0, s53, 49152
  s_nop 0
  buffer_load_dwordx4 v20, s[8:11], s51 offen lds
  s_add_u32 m0, s53, 50176
  s_nop 0
  buffer_load_dwordx4 v21, s[8:11], s51 offen lds
  s_add_u32 m0, s53, 51200
  s_nop 0
  buffer_load_dwordx4 v22, s[8:11], s51 offen lds
  s_add_u32 m0, s53, 52224
  s_nop 0
  buffer_load_dwordx4 v23, s[8:11], s51 offen lds
  s_add_u32 m0, s53, 53248
  s_nop 0
  buffer_load_dwordx4 v24, s[8:11], s51 offen lds
  s_add_u32 m0, s53, 54272
  s_nop 0
  buffer_load_dwordx4 v25, s[8:11], s51 offen lds
  s_add_u32 m0, s53, 55296
  s_nop 0
  buffer_load_dwordx4 v26, s[8:11], s51 offen lds
  s_add_u32 m0, s53, 56320
  s_nop 0
  buffer_load_dwordx4 v27, s[8:11], s51 offen lds
  s_add_u32 s51, s51, 128
  s_add_u32 m0, s53, 65536
  s_nop 0
  buffer_load_dwordx4 v20, s[8:11], s51 offen lds
  s_add_u32 m0, s53, 66560
  s_nop 0
  buffer_load_dwordx4 v21, s[8:11], s51 offen lds
  s_add_u32 m0, s53, 67584
  s_nop 0
  buffer_load_dwordx4 v22, s[8:11], s51 offen lds
  s_add_u32 m0, s53, 68608
  s_nop 0
  buffer_load_dwordx4 v23, s[8:11], s51 offen lds
  s_add_u32 m0, s53, 69632
  s_nop 0
  buffer_load_dwordx4 v24, s[8:11], s51 offen lds
  s_add_u32 m0, s53, 70656
  s_nop 0
  buffer_load_dwordx4 v25, s[8:11], s51 offen lds
  s_add_u32 m0, s53, 71680
  s_nop 0
  buffer_load_dwordx4 v26, s[8:11], s51 offen lds
  s_add_u32 m0, s53, 72704
  s_nop 0
  buffer_load_dwordx4 v27, s[8:11], s51 offen lds
  s_add_u32 s51, s51, 128
  s_add_u32 m0, s53, 81920
  s_nop 0
  buffer_load_dwordx4 v20, s[8:11], s51 offen lds
  s_add_u32 m0, s53, 82944
  s_nop 0
  buffer_load_dwordx4 v21, s[8:11], s51 offen lds
  s_add_u32 m0, s53, 83968
  s_nop 0
  buffer_load_dwordx4 v22, s[8:11], s51 offen lds
  s_add_u32 m0, s53, 84992
  s_nop 0
  buffer_load_dwordx4 v23, s[8:11], s51 offen lds
  s_add_u32 m0, s53, 86016
  s_nop 0
  buffer_load_dwordx4 v24, s[8:11], s51 offen lds
  s_add_u32 m0, s53, 87040
  s_nop 0
  buffer_load_dwordx4 v25, s[8:11], s51 offen lds
  s_add_u32 m0, s53, 88064
  s_nop 0
  buffer_load_dwordx4 v26, s[8:11], s51 offen lds
  s_add_u32 m0, s53, 89088
  s_nop 0
  buffer_load_dwordx4 v27, s[8:11], s51 offen lds
  s_add_u32 s51, s51, 128
  s_add_u32 m0, s53, 98304
  s_nop 0
  buffer_load_dwordx4 v20, s[8:11], s51 offen lds
  s_add_u32 m0, s53, 99328
  s_nop 0
  buffer_load_dwordx4 v21, s[8:11], s51 offen lds
  s_add_u32 m0, s53, 100352
  s_nop 0
  buffer_load_dwordx4 v22, s[8:11], s51 offen lds
  s_add_u32 m0, s53, 101376
  s_nop 0
  buffer_load_dwordx4 v23, s[8:11], s51 offen lds
  s_add_u32 m0, s53, 102400
  s_nop 0
  buffer_load_dwordx4 v24, s[8:11], s51 offen lds
  s_add_u32 m0, s53, 103424
  s_nop 0
  buffer_load_dwordx4 v25, s[8:11], s51 offen lds
  s_add_u32 m0, s53, 104448
  s_nop 0
  buffer_load_dwordx4 v26, s[8:11], s51 offen lds
  s_add_u32 m0, s53, 105472
  s_nop 0
  buffer_load_dwordx4 v27, s[8:11], s51 offen lds
  s_add_u32 s51, s51, 128
  s_waitcnt vmcnt(40)
  s_barrier
  s_waitcnt vmcnt(32)
  s_barrier
  s_add_u32 m0, s53, 0
  s_nop 0
  buffer_load_dwordx4 v20, s[8:11], s51 offen lds
  s_add_u32 m0, s53, 1024
  s_nop 0
  buffer_load_dwordx4 v21, s[8:11], s51 offen lds
  s_add_u32 m0, s53, 2048
  s_nop 0
  buffer_load_dwordx4 v22, s[8:11], s51 offen lds
  s_add_u32 m0, s53, 3072
  s_nop 0
  buffer_load_dwordx4 v23, s[8:11], s51 offen lds
  s_add_u32 m0, s53, 4096
  s_nop 0
  buffer_load_dwordx4 v24, s[8:11], s51 offen lds
  s_add_u32 m0, s53, 5120
  s_nop 0
  buffer_load_dwordx4 v25, s[8:11], s51 offen lds
  s_add_u32 m0, s53, 6144
  s_nop 0
  buffer_load_dwordx4 v26, s[8:11], s51 offen lds
  s_add_u32 m0, s53, 7168
  s_nop 0
  buffer_load_dwordx4 v27, s[8:11], s51 offen lds
  s_add_u32 s51, s51, 128
  s_waitcnt vmcnt(32)
  s_barrier
  s_add_u32 m0, s53, 16384
  s_nop 0
  buffer_load_dwordx4 v20, s[8:11], s51 offen lds
  s_add_u32 m0, s53, 17408
  s_nop 0
  buffer_load_dwordx4 v21, s[8:11], s51 offen lds
  s_add_u32 m0, s53, 18432
  s_nop 0
  buffer_load_dwordx4 v22, s[8:11], s51 offen lds
  s_add_u32 m0, s53, 19456
  s_nop 0
  buffer_load_dwordx4 v23, s[8:11], s51 offen lds
  s_add_u32 m0, s53, 20480
  s_nop 0
  buffer_load_dwordx4 v24, s[8:11], s51 offen lds
  s_add_u32 m0, s53, 21504
  s_nop 0
  buffer_load_dwordx4 v25, s[8:11], s51 offen lds
  s_add_u32 m0, s53, 22528
  s_nop 0
  buffer_load_dwordx4 v26, s[8:11], s51 offen lds
  s_add_u32 m0, s53, 23552
  s_nop 0
  buffer_load_dwordx4 v27, s[8:11], s51 offen lds
  s_add_u32 s51, s51, 128
  s_waitcnt vmcnt(32)
  s_barrier
  s_add_u32 m0, s53, 32768
  s_nop 0
  buffer_load_dwordx4 v20, s[8:11], s51 offen lds
  s_add_u32 m0, s53, 33792
  s_nop 0
  buffer_load_dwordx4 v21, s[8:11], s51 offen lds
  s_add_u32 m0, s53, 34816
  s_nop 0
  buffer_load_dwordx4 v22, s[8:11], s51 offen lds
  s_add_u32 m0, s53, 35840
  s_nop 0
  buffer_load_dwordx4 v23, s[8:11], s51 offen lds
  s_add_u32 m0, s53, 36864
  s_nop 0
  buffer_load_dwordx4 v24, s[8:11], s51 offen lds
  s_add_u32 m0, s53, 37888
  s_nop 0
  buffer_load_dwordx4 v25, s[8:11], s51 offen lds
  s_add_u32 m0, s53, 38912
  s_nop 0
  buffer_load_dwordx4 v26, s[8:11], s51 offen lds
  s_add_u32 m0, s53, 39936
  s_nop 0
  buffer_load_dwordx4 v27, s[8:11], s51 offen lds
  s_add_u32 s51, s51, 128
  s_waitcnt vmcnt(32)
  s_barrier
  s_add_u32 m0, s53, 49152
  s_nop 0
  buffer_load_dwordx4 v20, s[8:11], s51 offen lds
  s_add_u32 m0, s53, 50176
  s_nop 0
  buffer_load_dwordx4 v21, s[8:11], s51 offen lds
  s_add_u32 m0, s53, 51200
  s_nop 0
  buffer_load_dwordx4 v22, s[8:11], s51 offen lds
  s_add_u32 m0, s53, 52224
  s_nop 0
  buffer_load_dwordx4 v23, s[8:11], s51 offen lds
  s_add_u32 m0, s53, 53248
  s_nop 0
  buffer_load_dwordx4 v24, s[8:11], s51 offen lds
  s_add_u32 m0, s53, 54272
  s_nop 0
  buffer_load_dwordx4 v25, s[8:11], s51 offen lds
  s_add_u32 m0, s53, 55296
  s_nop 0
  buffer_load_dwordx4 v26, s[8:11], s51 offen lds
  s_add_u32 m0, s53, 56320
  s_nop 0
  buffer_load_dwordx4 v27, s[8:11], s51 offen lds
  s_add_u32 s51, s51, 128
  s_waitcnt vmcnt(32)
  s_barrier
  s_add_u32 m0, s53, 65536
  s_nop 0
  buffer_load_dwordx4 v20, s[8:11], s51 offen lds
  s_add_u32 m0, s53, 66560
  s_nop 0
  buffer_load_dwordx4 v21, s[8:11], s51 offen lds
  s_add_u32 m0, s53, 67584
  s_nop 0
  buffer_load_dwordx4 v22, s[8:11], s51 offen lds
  s_add_u32 m0, s53, 68608
  s_nop 0
  buffer_load_dwordx4 v23, s[8:11], s51 offen lds
  s_add_u32 m0, s53, 69632
  s_nop 0
  buffer_load_dwordx4 v24, s[8:11], s51 offen lds
  s_add_u32 m0, s53, 70656
  s_nop 0
  buffer_load_dwordx4 v25, s[8:11], s51 offen lds
  s_add_u32 m0, s53, 71680
  s_nop 0
  buffer_load_dwordx4 v26, s[8:11], s51 offen lds
  s_add_u32 m0, s53, 72704
  s_nop 0
  buffer_load_dwordx4 v27, s[8:11], s51 offen lds
  s_add_u32 s51, s51, 128
  s_waitcnt vmcnt(32)
  s_barrier
  s_add_u32 m0, s53, 81920
  s_nop 0
  buffer_load_dwordx4 v20, s[8:11], s51 offen lds
  s_add_u32 m0, s53, 82944
  s_nop 0
  buffer_load_dwordx4 v21, s[8:11], s51 offen lds
  s_add_u32 m0, s53, 83968
  s_nop 0
  buffer_load_dwordx4 v22, s[8:11], s51 offen lds
  s_add_u32 m0, s53, 84992
  s_nop 0
  buffer_load_dwordx4 v23, s[8:11], s51 offen lds
  s_add_u32 m0, s53, 86016
  s_nop 0
  buffer_load_dwordx4 v24, s[8:11], s51 offen lds
  s_add_u32 m0, s53, 87040
  s_nop 0
  buffer_load_dwordx4 v25, s[8:11], s51 offen lds
  s_add_u32 m0, s53, 88064
  s_nop 0
  buffer_load_dwordx4 v26, s[8:11], s51 offen lds
  s_add_u32 m0, s53, 89088
  s_nop 0
  buffer_load_dwordx4 v27, s[8:11], s51 offen lds
  s_add_u32 s51, s51, 128
  s_waitcnt vmcnt(32)
  s_mov_b32 s55, 2
gemm2_kernel_l_loop0:
  s_barrier
  s_add_u32 m0, s53, 98304
  s_nop 0
  buffer_load_dwordx4 v20, s[8:11], s51 offen lds
  s_add_u32 m0, s53, 99328
  s_nop 0
  buffer_load_dwordx4 v21, s[8:11], s51 offen lds
  s_add_u32 m0, s53, 100352
  s_nop 0
  buffer_load_dwordx4 v22, s[8:11], s51 offen lds
  s_add_u32 m0, s53, 101376
  s_nop 0
  buffer_load_dwordx4 v23, s[8:11], s51 offen lds
  s_add_u32 m0, s53, 102400
  s_nop 0
  buffer_load_dwordx4 v24, s[8:11], s51 offen lds
  s_add_u32 m0, s53, 103424
  s_nop 0
  buffer_load_dwordx4 v25, s[8:11], s51 offen lds
  s_add_u32 m0, s53, 104448
  s_nop 0
  buffer_load_dwordx4 v26, s[8:11], s51 offen lds
  s_add_u32 m0, s53, 105472
  s_nop 0
  buffer_load_dwordx4 v27, s[8:11], s51 offen lds
  s_add_u32 s51, s51, 128
  s_waitcnt vmcnt(32)
  s_barrier
  s_add_u32 m0, s53, 0
  s_nop 0
  buffer_load_dwordx4 v20, s[8:11], s51 offen lds
  s_add_u32 m0, s53, 1024
  s_nop 0
  buffer_load_dwordx4 v21, s[8:11], s51 offen lds
  s_add_u32 m0, s53, 2048
  s_nop 0
  buffer_load_dwordx4 v22, s[8:11], s51 offen lds
  s_add_u32 m0, s53, 3072
  s_nop 0
  buffer_load_dwordx4 v23, s[8:11], s51 offen lds
  s_add_u32 m0, s53, 4096
  s_nop 0
  buffer_load_dwordx4 v24, s[8:11], s51 offen lds
  s_add_u32 m0, s53, 5120
  s_nop 0
  buffer_load_dwordx4 v25, s[8:11], s51 offen lds
  s_add_u32 m0, s53, 6144
  s_nop 0
  buffer_load_dwordx4 v26, s[8:11], s51 offen lds
  s_add_u32 m0, s53, 7168
  s_nop 0
  buffer_load_dwordx4 v27, s[8:11], s51 offen lds
  s_add_u32 s51, s51, 128
  s_waitcnt vmcnt(32)
  s_barrier
  s_add_u32 m0, s53, 16384
  s_nop 0
  buffer_load_dwordx4 v20, s[8:11], s51 offen lds
  s_add_u32 m0, s53, 17408
  s_nop 0
  buffer_load_dwordx4 v21, s[8:11], s51 offen lds
  s_add_u32 m0, s53, 18432
  s_nop 0
  buffer_load_dwordx4 v22, s[8:11], s51 offen lds
  s_add_u32 m0, s53, 19456
  s_nop 0
  buffer_load_dwordx4 v23, s[8:11], s51 offen lds
  s_add_u32 m0, s53, 20480
  s_nop 0
  buffer_load_dwordx4 v24, s[8:11], s51 offen lds
  s_add_u32 m0, s53, 21504
  s_nop 0
  buffer_load_dwordx4 v25, s[8:11], s51 offen lds
  s_add_u32 m0, s53, 22528
  s_nop 0
  buffer_load_dwordx4 v26, s[8:11], s51 offen lds
  s_add_u32 m0, s53, 23552
  s_nop 0
  buffer_load_dwordx4 v27, s[8:11], s51 offen lds
  s_add_u32 s51, s51, 128
  s_waitcnt vmcnt(32)
  s_barrier
  s_add_u32 m0, s53, 32768
  s_nop 0
  buffer_load_dwordx4 v20, s[8:11], s51 offen lds
  s_add_u32 m0, s53, 33792
  s_nop 0
  buffer_load_dwordx4 v21, s[8:11], s51 offen lds
  s_add_u32 m0, s53, 34816
  s_nop 0
  buffer_load_dwordx4 v22, s[8:11], s51 offen lds
  s_add_u32 m0, s53, 35840
  s_nop 0
  buffer_load_dwordx4 v23, s[8:11], s51 offen lds
  s_add_u32 m0, s53, 36864
  s_nop 0
  buffer_load_dwordx4 v24, s[8:11], s51 offen lds
  s_add_u32 m0, s53, 37888
  s_nop 0
  buffer_load_dwordx4 v25, s[8:11], s51 offen lds
  s_add_u32 m0, s53, 38912
  s_nop 0
  buffer_load_dwordx4 v26, s[8:11], s51 offen lds
  s_add_u32 m0, s53, 39936
  s_nop 0
  buffer_load_dwordx4 v27, s[8:11], s51 offen lds
  s_add_u32 s51, s51, 128
  s_waitcnt vmcnt(32)
  s_barrier
  s_add_u32 m0, s53, 49152
  s_nop 0
  buffer_load_dwordx4 v20, s[8:11], s51 offen lds
  s_add_u32 m0, s53, 50176
  s_nop 0
  buffer_load_dwordx4 v21, s[8:11], s51 offen lds
  s_add_u32 m0, s53, 51200
  s_nop 0
  buffer_load_dwordx4 v22, s[8:11], s51 offen lds
  s_add_u32 m0, s53, 52224
  s_nop 0
  buffer_load_dwordx4 v23, s[8:11], s51 offen lds
  s_add_u32 m0, s53, 53248
  s_nop 0
  buffer_load_dwordx4 v24, s[8:11], s51 offen lds
  s_add_u32 m0, s53, 54272
  s_nop 0
  buffer_load_dwordx4 v25, s[8:11], s51 offen lds
  s_add_u32 m0, s53, 55296
  s_nop 0
  buffer_load_dwordx4 v26, s[8:11], s51 offen lds
  s_add_u32 m0, s53, 56320
  s_nop 0
  buffer_load_dwordx4 v27, s[8:11], s51 offen lds
  s_add_u32 s51, s51, 128
  s_waitcnt vmcnt(32)
  s_barrier
  s_add_u32 m0, s53, 65536
  s_nop 0
  buffer_load_dwordx4 v20, s[8:11], s51 offen lds
  s_add_u32 m0, s53, 66560
  s_nop 0
  buffer_load_dwordx4 v21, s[8:11], s51 offen lds
  s_add_u32 m0, s53, 67584
  s_nop 0
  buffer_load_dwordx4 v22, s[8:11], s51 offen lds
  s_add_u32 m0, s53, 68608
  s_nop 0
  buffer_load_dwordx4 v23, s[8:11], s51 offen lds
  s_add_u32 m0, s53, 69632
  s_nop 0
  buffer_load_dwordx4 v24, s[8:11], s51 offen lds
  s_add_u32 m0, s53, 70656
  s_nop 0
  buffer_load_dwordx4 v25, s[8:11], s51 offen lds
  s_add_u32 m0, s53, 71680
  s_nop 0
  buffer_load_dwordx4 v26, s[8:11], s51 offen lds
  s_add_u32 m0, s53, 72704
  s_nop 0
  buffer_load_dwordx4 v27, s[8:11], s51 offen lds
  s_add_u32 s51, s51, 128
  s_waitcnt vmcnt(32)
  s_barrier
  s_add_u32 m0, s53, 81920
  s_nop 0
  buffer_load_dwordx4 v20, s[8:11], s51 offen lds
  s_add_u32 m0, s53, 82944
  s_nop 0
  buffer_load_dwordx4 v21, s[8:11], s51 offen lds
  s_add_u32 m0, s53, 83968
  s_nop 0
  buffer_load_dwordx4 v22, s[8:11], s51 offen lds
  s_add_u32 m0, s53, 84992
  s_nop 0
  buffer_load_dwordx4 v23, s[8:11], s51 offen lds
  s_add_u32 m0, s53, 86016
  s_nop 0
  buffer_load_dwordx4 v24, s[8:11], s51 offen lds
  s_add_u32 m0, s53, 87040
  s_nop 0
  buffer_load_dwordx4 v25, s[8:11], s51 offen lds
  s_add_u32 m0, s53, 88064
  s_nop 0
  buffer_load_dwordx4 v26, s[8:11], s51 offen lds
  s_add_u32 m0, s53, 89088
  s_nop 0
  buffer_load_dwordx4 v27, s[8:11], s51 offen lds
  s_add_u32 s51, s51, 128
  s_waitcnt vmcnt(32)
  s_sub_u32 s55, s55, 1
  s_cmp_lg_u32 s55, 0
  s_cbranch_scc1 gemm2_kernel_l_loop0
  s_barrier
  s_add_u32 m0, s53, 98304
  s_nop 0
  buffer_load_dwordx4 v20, s[8:11], s51 offen lds
  s_add_u32 m0, s53, 99328
  s_nop 0
  buffer_load_dwordx4 v21, s[8:11], s51 offen lds
  s_add_u32 m0, s53, 100352
  s_nop 0
  buffer_load_dwordx4 v22, s[8:11], s51 offen lds
  s_add_u32 m0, s53, 101376
  s_nop 0
  buffer_load_dwordx4 v23, s[8:11], s51 offen lds
  s_add_u32 m0, s53, 102400
  s_nop 0
  buffer_load_dwordx4 v24, s[8:11], s51 offen lds
  s_add_u32 m0, s53, 103424
  s_nop 0
  buffer_load_dwordx4 v25, s[8:11], s51 offen lds
  s_add_u32 m0, s53, 104448
  s_nop 0
  buffer_load_dwordx4 v26, s[8:11], s51 offen lds
  s_add_u32 m0, s53, 105472
  s_nop 0
  buffer_load_dwordx4 v27, s[8:11], s51 offen lds
  s_add_u32 s51, s51, 128
  s_waitcnt vmcnt(32)
  s_barrier
  s_add_u32 m0, s53, 0
  s_nop 0
  buffer_load_dwordx4 v20, s[8:11], s51 offen lds
  s_add_u32 m0, s53, 1024
  s_nop 0
  buffer_load_dwordx4 v21, s[8:11], s51 offen lds
  s_add_u32 m0, s53, 2048
  s_nop 0
  buffer_load_dwordx4 v22, s[8:11], s51 offen lds
  s_add_u32 m0, s53, 3072
  s_nop 0
  buffer_load_dwordx4 v23, s[8:11], s51 offen lds
  s_add_u32 m0, s53, 4096
  s_nop 0
  buffer_load_dwordx4 v24, s[8:11], s51 offen lds
  s_add_u32 m0, s53, 5120
  s_nop 0
  buffer_load_dwordx4 v25, s[8:11], s51 offen lds
  s_add_u32 m0, s53, 6144
  s_nop 0
  buffer_load_dwordx4 v26, s[8:11], s51 offen lds
  s_add_u32 m0, s53, 7168
  s_nop 0
  buffer_load_dwordx4 v27, s[8:11], s51 offen lds
  s_add_u32 s51, s51, 128
  s_waitcnt vmcnt(32)
  s_barrier
  s_add_u32 m0, s53, 16384
  s_nop 0
  buffer_load_dwordx4 v20, s[8:11], s51 offen lds
  s_add_u32 m0, s53, 17408
  s_nop 0
  buffer_load_dwordx4 v21, s[8:11], s51 offen lds
  s_add_u32 m0, s53, 18432
  s_nop 0
  buffer_load_dwordx4 v22, s[8:11], s51 offen lds
  s_add_u32 m0, s53, 19456
  s_nop 0
  buffer_load_dwordx4 v23, s[8:11], s51 offen lds
  s_add_u32 m0, s53, 20480
  s_nop 0
  buffer_load_dwordx4 v24, s[8:11], s51 offen lds
  s_add_u32 m0, s53, 21504
  s_nop 0
  buffer_load_dwordx4 v25, s[8:11], s51 offen lds
  s_add_u32 m0, s53, 22528
  s_nop 0
  buffer_load_dwordx4 v26, s[8:11], s51 offen lds
  s_add_u32 m0, s53, 23552
  s_nop 0
  buffer_load_dwordx4 v27, s[8:11], s51 offen lds
  s_add_u32 s51, s51, 128
  s_waitcnt vmcnt(32)
  s_barrier
  s_add_u32 m0, s53, 32768
  s_nop 0
  buffer_load_dwordx4 v20, s[8:11], s51 offen lds
  s_add_u32 m0, s53, 33792
  s_nop 0
  buffer_load_dwordx4 v21, s[8:11], s51 offen lds
  s_add_u32 m0, s53, 34816
  s_nop 0
  buffer_load_dwordx4 v22, s[8:11], s51 offen lds
  s_add_u32 m0, s53, 35840
  s_nop 0
  buffer_load_dwordx4 v23, s[8:11], s51 offen lds
  s_add_u32 m0, s53, 36864
  s_nop 0
  buffer_load_dwordx4 v24, s[8:11], s51 offen lds
  s_add_u32 m0, s53, 37888
  s_nop 0
  buffer_load_dwordx4 v25, s[8:11], s51 offen lds
  s_add_u32 m0, s53, 38912
  s_nop 0
  buffer_load_dwordx4 v26, s[8:11], s51 offen lds
  s_add_u32 m0, s53, 39936
  s_nop 0
  buffer_load_dwordx4 v27, s[8:11], s51 offen lds
  s_add_u32 s51, s51, 128
  s_waitcnt vmcnt(32)
  s_barrier
  s_add_u32 m0, s53, 49152
  s_nop 0
  buffer_load_dwordx4 v20, s[8:11], s51 offen lds
  s_add_u32 m0, s53, 50176
  s_nop 0
  buffer_load_dwordx4 v21, s[8:11], s51 offen lds
  s_add_u32 m0, s53, 51200
  s_nop 0
  buffer_load_dwordx4 v22, s[8:11], s51 offen lds
  s_add_u32 m0, s53, 52224
  s_nop 0
  buffer_load_dwordx4 v23, s[8:11], s51 offen lds
  s_add_u32 m0, s53, 53248
  s_nop 0
  buffer_load_dwordx4 v24, s[8:11], s51 offen lds
  s_add_u32 m0, s53, 54272
  s_nop 0
  buffer_load_dwordx4 v25, s[8:11], s51 offen lds
  s_add_u32 m0, s53, 55296
  s_nop 0
  buffer_load_dwordx4 v26, s[8:11], s51 offen lds
  s_add_u32 m0, s53, 56320
  s_nop 0
  buffer_load_dwordx4 v27, s[8:11], s51 offen lds
  s_add_u32 s51, s51, 128
  s_waitcnt vmcnt(32)
  s_barrier
  s_waitcnt vmcnt(24)
  s_barrier
  s_waitcnt vmcnt(16)
  s_barrier
  s_waitcnt vmcnt(8)
  s_barrier
  s_waitcnt vmcnt(0)
  s_barrier
  s_barrier
  s_endpgm
gemm2_kernel_bw:
  s_sub_u32 s50, s50, 4
  s_mul_i32 s56, s49, 128
  s_add_u32 s56, s56, 1792
  s_mov_b32 s57, 3584
  v_lshrrev_b32 v3, 3, v1
  v_mul_u32_u24 v4, 16, v2
  v_add3_u32 v3, v3, v4, 0
  v_lshlrev_b32 v22, 3, v3
  v_add_u32 v22, 147456, v22
  v_bfe_u32 v4, v3, 1, 1
  v_lshlrev_b32 v4, 2, v4
  v_and_b32 v5, 7, v1
  v_xor_b32 v5, v5, v4
  v_lshlrev_b32 v5, 4, v5
  v_mul_lo_u32 v3, v3, s57
  v_add3_u32 v20, v3, v5, s56
  v_lshrrev_b32 v3, 3, v1
  v_mul_u32_u24 v4, 16, v2
  v_add3_u32 v3, v3, v4, 8
  v_lshlrev_b32 v23, 3, v3
  v_add_u32 v23, 147456, v23
  v_bfe_u32 v4, v3, 1, 1
  v_lshlrev_b32 v4, 2, v4
  v_and_b32 v5, 7, v1
  v_xor_b32 v5, v5, v4
  v_lshlrev_b32 v5, 4, v5
  v_mul_lo_u32 v3, v3, s57
  v_add3_u32 v21, v3, v5, s56
  v_mul_u32_u24 v3, 2048, v2
  v_lshl_add_u32 v24, v1, 4, v3
  v_add_u32 v24, 114688, v24
  s_mov_b32 s52, 0
  s_waitcnt lgkmcnt(0)
  s_mov_b32 s12, s46
  s_mov_b32 s13, s47
  s_and_b32 s13, s13, 0xffff
  s_mov_b32 s14, 0x700000
  s_mov_b32 s15, 0x20000
  s_add_u32 s24, s46, 0x800000
  s_addc_u32 s25, s47, 0
  s_and_b32 s25, s25, 0xffff
  s_mov_b32 s26, 0x1c000
  s_mov_b32 s27, 0x20000
  s_add_u32 s16, s46, 0x900000
  s_addc_u32 s17, s47, 0
  s_and_b32 s17, s17, 0xffff
  s_mov_b32 s18, 0x380000
  s_mov_b32 s19, 0x20000
  s_mov_b32 s20, s46
  s_mov_b32 s21, s47
  s_and_b32 s21, s21, 0xffff
  s_mov_b32 s22, 0x700000
  s_mov_b32 s23, 0x20000
  v_lshlrev_b32 v130, 4, v0
  s_mov_b32 s56, 0
  buffer_load_dwordx4 v[74:77], v130, s[24:27], s56 offen
  s_mov_b32 s56, 16384
  buffer_load_dwordx4 v[78:81], v130, s[24:27], s56 offen
  s_mov_b32 s56, 32768
  buffer_load_dwordx4 v[82:85], v130, s[24:27], s56 offen
  s_mov_b32 s56, 49152
  buffer_load_dwordx4 v[86:89], v130, s[24:27], s56 offen
  s_mov_b32 s56, 65536
  buffer_load_dwordx4 v[90:93], v130, s[24:27], s56 offen
  s_mov_b32 s56, 81920
  buffer_load_dwordx4 v[94:97], v130, s[24:27], s56 offen
  s_mov_b32 s56, 98304
  buffer_load_dwordx4 v[98:101], v130, s[24:27], s56 offen
  s_mov_b32 s56, 8192
  buffer_load_dwordx4 v[102:105], v130, s[24:27], s56 offen
  s_mov_b32 s56, 24576
  buffer_load_dwordx4 v[106:109], v130, s[24:27], s56 offen
  s_mov_b32 s56, 40960
  buffer_load_dwordx4 v[110:113], v130, s[24:27], s56 offen
  s_mov_b32 s56, 57344
  buffer_load_dwordx4 v[114:117], v130, s[24:27], s56 offen
  s_mov_b32 s56, 73728
  buffer_load_dwordx4 v[118:121], v130, s[24:27], s56 offen
  s_mov_b32 s56, 90112
  buffer_load_dwordx4 v[122:125], v130, s[24:27], s56 offen
  s_mov_b32 s56, 106496
  buffer_load_dwordx4 v[126:129], v130, s[24:27], s56 offen
  buffer_load_dwordx4 v[26:29], v20, s[12:15], s52 offen
  buffer_load_dwordx4 v[30:33], v21, s[12:15], s52 offen
  s_add_u32 s52, s52, 229376
  buffer_load_dwordx4 v[34:37], v20, s[12:15], s52 offen
  buffer_load_dwordx4 v[38:41], v21, s[12:15], s52 offen
  s_add_u32 s52, s52, 229376
  v_mov_b32 v148, 0x43000000
  v_add_u32 v130, 147456, v130
  s_waitcnt vmcnt(4)
  v_add_f32 v131, v74, v78
  v_add_f32 v135, v75, v79
  v_add_f32 v132, v76, v80
  v_add_f32 v136, v77, v81
  v_add_f32 v133, v102, v106
  v_add_f32 v137, v103, v107
  v_add_f32 v134, v104, v108
  v_add_f32 v138, v105, v109
  v_add_f32 v131, v131, v82
  v_add_f32 v135, v135, v83
  v_add_f32 v132, v132, v84
  v_add_f32 v136, v136, v85
  v_add_f32 v133, v133, v110
  v_add_f32 v137, v137, v111
  v_add_f32 v134, v134, v112
  v_add_f32 v138, v138, v113
  v_add_f32 v131, v131, v86
  v_add_f32 v135, v135, v87
  v_add_f32 v132, v132, v88
  v_add_f32 v136, v136, v89
  v_add_f32 v133, v133, v114
  v_add_f32 v137, v137, v115
  v_add_f32 v134, v134, v116
  v_add_f32 v138, v138, v117
  v_add_f32 v131, v131, v90
  v_add_f32 v135, v135, v91
  v_add_f32 v132, v132, v92
  v_add_f32 v136, v136, v93
  v_add_f32 v133, v133, v118
  v_add_f32 v137, v137, v119
  v_add_f32 v134, v134, v120
  v_add_f32 v138, v138, v121
  v_add_f32 v131, v131, v94
  v_add_f32 v135, v135, v95
  v_add_f32 v132, v132, v96
  v_add_f32 v136, v136, v97
  v_add_f32 v133, v133, v122
  v_add_f32 v137, v137, v123
  v_add_f32 v134, v134, v124
  v_add_f32 v138, v138, v125
  v_add_f32 v131, v131, v98
  v_add_f32 v135, v135, v99
  v_add_f32 v132, v132, v100
  v_add_f32 v136, v136, v101
  v_add_f32 v133, v133, v126
  v_add_f32 v137, v137, v127
  v_add_f32 v134, v134, v128
  v_add_f32 v138, v138, v129
  v_mul_f32 v131, 0x3e124925, v131
  v_mov_b32 v144, 0
  v_mul_f32 v132, 0x3e124925, v132
  v_mov_b32 v145, 0
  v_mul_f32 v133, 0x3e124925, v133
  v_mov_b32 v146, 0
  v_mul_f32 v134, 0x3e124925, v134
  v_mov_b32 v147, 0
  v_sub_f32 v140, v74, v131
  v_sub_f32 v141, v76, v132
  v_sub_f32 v142, v102, v133
  v_sub_f32 v143, v104, v134
  v_fmac_f32 v144, v140, v140
  v_fmac_f32 v145, v141, v141
  v_fmac_f32 v146, v142, v142
  v_fmac_f32 v147, v143, v143
  v_sub_f32 v140, v78, v131
  v_sub_f32 v141, v80, v132
  v_sub_f32 v142, v106, v133
  v_sub_f32 v143, v108, v134
  v_fmac_f32 v144, v140, v140
  v_fmac_f32 v145, v141, v141
  v_fmac_f32 v146, v142, v142
  v_fmac_f32 v147, v143, v143
  v_sub_f32 v140, v82, v131
  v_sub_f32 v141, v84, v132
  v_sub_f32 v142, v110, v133
  v_sub_f32 v143, v112, v134
  v_fmac_f32 v144, v140, v140
  v_fmac_f32 v145, v141, v141
  v_fmac_f32 v146, v142, v142
  v_fmac_f32 v147, v143, v143
  v_sub_f32 v140, v86, v131
  v_sub_f32 v141, v88, v132
  v_sub_f32 v142, v114, v133
  v_sub_f32 v143, v116, v134
  v_fmac_f32 v144, v140, v140
  v_fmac_f32 v145, v141, v141
  v_fmac_f32 v146, v142, v142
  v_fmac_f32 v147, v143, v143
  v_sub_f32 v140, v90, v131
  v_sub_f32 v141, v92, v132
  v_sub_f32 v142, v118, v133
  v_sub_f32 v143, v120, v134
  v_fmac_f32 v144, v140, v140
  v_fmac_f32 v145, v141, v141
  v_fmac_f32 v146, v142, v142
  v_fmac_f32 v147, v143, v143
  v_sub_f32 v140, v94, v131
  v_sub_f32 v141, v96, v132
  v_sub_f32 v142, v122, v133
  v_sub_f32 v143, v124, v134
  v_fmac_f32 v144, v140, v140
  v_fmac_f32 v145, v141, v141
  v_fmac_f32 v146, v142, v142
  v_fmac_f32 v147, v143, v143
  v_sub_f32 v140, v98, v131
  v_sub_f32 v141, v100, v132
  v_sub_f32 v142, v126, v133
  v_sub_f32 v143, v128, v134
  v_fmac_f32 v144, v140, v140
  v_fmac_f32 v145, v141, v141
  v_fmac_f32 v146, v142, v142
  v_fmac_f32 v147, v143, v143
  v_fmac_f32 v135, v144, v148
  v_fmac_f32 v136, v145, v148
  v_fmac_f32 v137, v146, v148
  v_fmac_f32 v138, v147, v148
  v_mul_f32 v135, 0x3a924925, v135
  v_mul_f32 v136, 0x3a924925, v136
  v_mul_f32 v137, 0x3a924925, v137
  v_mul_f32 v138, 0x3a924925, v138
  v_cvt_pk_bf16_f32 v140, v131, v135
  v_cvt_pk_bf16_f32 v141, v132, v136
  v_cvt_pk_bf16_f32 v142, v133, v137
  v_cvt_pk_bf16_f32 v143, v134, v138
  v_lshlrev_b32 v131, 16, v140
  v_and_b32 v135, 0xffff0000, v140
  v_lshlrev_b32 v132, 16, v141
  v_and_b32 v136, 0xffff0000, v141
  v_lshlrev_b32 v133, 16, v142
  v_and_b32 v137, 0xffff0000, v142
  v_lshlrev_b32 v134, 16, v143
  v_and_b32 v138, 0xffff0000, v143
  v_add_f32 v135, 0x3727c5ac, v135
  v_add_f32 v136, 0x3727c5ac, v136
  v_add_f32 v137, 0x3727c5ac, v137
  v_add_f32 v138, 0x3727c5ac, v138
  v_cvt_pk_bf16_f32 v135, v135, v135
  v_cvt_pk_bf16_f32 v136, v136, v136
  v_cvt_pk_bf16_f32 v137, v137, v137
  v_cvt_pk_bf16_f32 v138, v138, v138
  v_lshlrev_b32 v135, 16, v135
  v_lshlrev_b32 v136, 16, v136
  v_lshlrev_b32 v137, 16, v137
  v_lshlrev_b32 v138, 16, v138
  v_sqrt_f32 v135, v135
  v_sqrt_f32 v136, v136
  v_sqrt_f32 v137, v137
  v_sqrt_f32 v138, v138
  v_cvt_pk_bf16_f32 v135, v135, v135
  v_cvt_pk_bf16_f32 v136, v136, v136
  v_cvt_pk_bf16_f32 v137, v137, v137
  v_cvt_pk_bf16_f32 v138, v138, v138
  v_lshlrev_b32 v135, 16, v135
  v_lshlrev_b32 v136, 16, v136
  v_lshlrev_b32 v137, 16, v137
  v_lshlrev_b32 v138, 16, v138
  v_rcp_f32 v140, v135
  v_rcp_f32 v142, v136
  v_rcp_f32 v144, v137
  v_rcp_f32 v146, v138
  v_mul_f32 v141, v131, v140
  v_mul_f32 v143, v132, v142
  v_mul_f32 v145, v133, v144
  v_mul_f32 v147, v134, v146
  v_sub_f32 v141, 0, v141
  v_sub_f32 v143, 0, v143
  v_sub_f32 v145, 0, v145
  v_sub_f32 v147, 0, v147
  ds_write_b128 v130, v[140:143] offset:0
  ds_write_b128 v130, v[144:147] offset:8192
  s_waitcnt lgkmcnt(0)
  s_barrier
  buffer_load_dwordx4 v[42:45], v20, s[12:15], s52 offen
  buffer_load_dwordx4 v[46:49], v21, s[12:15], s52 offen
  s_add_u32 s52, s52, 229376
  buffer_load_dwordx4 v[50:53], v20, s[12:15], s52 offen
  buffer_load_dwordx4 v[54:57], v21, s[12:15], s52 offen
  s_add_u32 s52, s52, 229376
  buffer_load_dwordx4 v[58:61], v20, s[12:15], s52 offen
  buffer_load_dwordx4 v[62:65], v21, s[12:15], s52 offen
  s_add_u32 s52, s52, 229376
  buffer_load_dwordx4 v[66:69], v20, s[12:15], s52 offen
  buffer_load_dwordx4 v[70:73], v21, s[12:15], s52 offen
  s_add_u32 s52, s52, 229376
  ds_read_b64 v[74:75], v22
  ds_read_b64 v[76:77], v23
  v_add_u32 v22, 512, v22
  v_add_u32 v23, 512, v23
  ds_read_b64 v[78:79], v22
  ds_read_b64 v[80:81], v23
  v_add_u32 v22, 512, v22
  v_add_u32 v23, 512, v23
  v_lshrrev_b32 v7, 3, v0
  v_and_b32 v3, 7, v0
  v_mul_u32_u24 v4, 272, v7
  v_lshl_add_u32 v8, v3, 5, v4
  s_mul_i32 s56, s48, 128
  v_add_u32 v4, s56, v7
  s_mov_b32 s57, 1792
  v_mul_lo_u32 v5, v4, s57
  s_mul_i32 s56, s49, 128
  v_lshl_add_u32 v6, v3, 4, v5
  v_add_u32 v9, s56, v6
  s_mov_b32 s57, 3584
  v_mul_lo_u32 v5, v4, s57
  v_lshl_add_u32 v5, v3, 4, v5
  s_mul_i32 s56, s49, 128
  v_add_u32 v5, s56, v5
  s_mov_b32 s56, 0
  buffer_load_dwordx4 v[10:13], v5, s[20:23], s56 offen
  s_mov_b32 s56, 229376
  buffer_load_dwordx4 v[14:17], v5, s[20:23], s56 offen
  s_mov_b32 s28, s38
  s_mov_b32 s29, s39
  s_and_b32 s29, s29, 0xffff
  s_mov_b32 s30, 0x1000
  s_mov_b32 s31, 0x20000
  v_lshlrev_b32 v6, 1, v4
  buffer_load_ushort v18, v6, s[28:31], 0 offen offset:0
  buffer_load_ushort v19, v6, s[28:31], 0 offen offset:128
  s_waitcnt vmcnt(14) lgkmcnt(0)
  v_lshlrev_b32 v82, 16, v26
  v_and_b32 v83, 0xffff0000, v26
  v_lshlrev_b32 v90, 16, v30
  v_and_b32 v91, 0xffff0000, v30
  v_lshlrev_b32 v84, 16, v27
  v_and_b32 v85, 0xffff0000, v27
  v_lshlrev_b32 v92, 16, v31
  v_and_b32 v93, 0xffff0000, v31
  v_lshlrev_b32 v86, 16, v28
  v_and_b32 v87, 0xffff0000, v28
  v_lshlrev_b32 v94, 16, v32
  v_and_b32 v95, 0xffff0000, v32
  v_lshlrev_b32 v88, 16, v29
  v_and_b32 v89, 0xffff0000, v29
  v_lshlrev_b32 v96, 16, v33
  v_and_b32 v97, 0xffff0000, v33
  v_fma_f32 v82, v82, v74, v75
  v_fma_f32 v83, v83, v74, v75
  v_fma_f32 v90, v90, v76, v77
  v_fma_f32 v91, v91, v76, v77
  v_fma_f32 v84, v84, v74, v75
  v_fma_f32 v85, v85, v74, v75
  v_fma_f32 v92, v92, v76, v77
  v_fma_f32 v93, v93, v76, v77
  v_fma_f32 v86, v86, v74, v75
  v_fma_f32 v87, v87, v74, v75
  v_fma_f32 v94, v94, v76, v77
  v_fma_f32 v95, v95, v76, v77
  v_fma_f32 v88, v88, v74, v75
  v_fma_f32 v89, v89, v74, v75
  v_fma_f32 v96, v96, v76, v77
  v_fma_f32 v97, v97, v76, v77
  v_cvt_pk_bf16_f32 v98, v82, v83
  v_cvt_pk_bf16_f32 v102, v90, v91
  v_cvt_pk_bf16_f32 v99, v84, v85
  v_cvt_pk_bf16_f32 v103, v92, v93
  v_cvt_pk_bf16_f32 v100, v86, v87
  v_cvt_pk_bf16_f32 v104, v94, v95
  v_cvt_pk_bf16_f32 v101, v88, v89
  v_cvt_pk_bf16_f32 v105, v96, v97
  ds_write_b128 v24, v[98:101] offset:0
  ds_write_b128 v24, v[102:105] offset:1024
  ds_read_b64 v[74:75], v22
  ds_read_b64 v[76:77], v23
  v_add_u32 v22, 512, v22
  v_add_u32 v23, 512, v23
  s_waitcnt vmcnt(12)
  v_lshlrev_b32 v82, 16, v34
  v_and_b32 v83, 0xffff0000, v34
  v_lshlrev_b32 v90, 16, v38
  v_and_b32 v91, 0xffff0000, v38
  v_lshlrev_b32 v84, 16, v35
  v_and_b32 v85, 0xffff0000, v35
  v_lshlrev_b32 v92, 16, v39
  v_and_b32 v93, 0xffff0000, v39
  v_lshlrev_b32 v86, 16, v36
  v_and_b32 v87, 0xffff0000, v36
  v_lshlrev_b32 v94, 16, v40
  v_and_b32 v95, 0xffff0000, v40
  v_lshlrev_b32 v88, 16, v37
  v_and_b32 v89, 0xffff0000, v37
  v_lshlrev_b32 v96, 16, v41
  v_and_b32 v97, 0xffff0000, v41
  v_fma_f32 v82, v82, v78, v79
  v_fma_f32 v83, v83, v78, v79
  v_fma_f32 v90, v90, v80, v81
  v_fma_f32 v91, v91, v80, v81
  v_fma_f32 v84, v84, v78, v79
  v_fma_f32 v85, v85, v78, v79
  v_fma_f32 v92, v92, v80, v81
  v_fma_f32 v93, v93, v80, v81
  v_fma_f32 v86, v86, v78, v79
  v_fma_f32 v87, v87, v78, v79
  v_fma_f32 v94, v94, v80, v81
  v_fma_f32 v95, v95, v80, v81
  v_fma_f32 v88, v88, v78, v79
  v_fma_f32 v89, v89, v78, v79
  v_fma_f32 v96, v96, v80, v81
  v_fma_f32 v97, v97, v80, v81
  v_cvt_pk_bf16_f32 v106, v82, v83
  v_cvt_pk_bf16_f32 v110, v90, v91
  v_cvt_pk_bf16_f32 v107, v84, v85
  v_cvt_pk_bf16_f32 v111, v92, v93
  v_cvt_pk_bf16_f32 v108, v86, v87
  v_cvt_pk_bf16_f32 v112, v94, v95
  v_cvt_pk_bf16_f32 v109, v88, v89
  v_cvt_pk_bf16_f32 v113, v96, v97
  ds_write_b128 v24, v[106:109] offset:8192
  ds_write_b128 v24, v[110:113] offset:9216
  s_waitcnt lgkmcnt(0)
  ds_read_b64 v[78:79], v22
  ds_read_b64 v[80:81], v23
  v_add_u32 v22, 512, v22
  v_add_u32 v23, 512, v23
  s_waitcnt vmcnt(10)
  buffer_load_dwordx4 v[26:29], v20, s[12:15], s52 offen
  v_lshlrev_b32 v82, 16, v42
  v_and_b32 v83, 0xffff0000, v42
  v_lshlrev_b32 v90, 16, v46
  v_and_b32 v91, 0xffff0000, v46
  v_lshlrev_b32 v84, 16, v43
  v_and_b32 v85, 0xffff0000, v43
  v_lshlrev_b32 v92, 16, v47
  v_and_b32 v93, 0xffff0000, v47
  v_lshlrev_b32 v86, 16, v44
  v_and_b32 v87, 0xffff0000, v44
  buffer_load_dwordx4 v[30:33], v21, s[12:15], s52 offen
  s_add_u32 s52, s52, 229376
  v_lshlrev_b32 v94, 16, v48
  v_and_b32 v95, 0xffff0000, v48
  v_lshlrev_b32 v88, 16, v45
  v_and_b32 v89, 0xffff0000, v45
  v_lshlrev_b32 v96, 16, v49
  v_and_b32 v97, 0xffff0000, v49
  v_fma_f32 v82, v82, v74, v75
  v_fma_f32 v83, v83, v74, v75
  v_fma_f32 v90, v90, v76, v77
  v_fma_f32 v91, v91, v76, v77
  buffer_load_dwordx4 v[34:37], v20, s[12:15], s52 offen
  v_fma_f32 v84, v84, v74, v75
  v_fma_f32 v85, v85, v74, v75
  v_fma_f32 v92, v92, v76, v77
  v_fma_f32 v93, v93, v76, v77
  v_fma_f32 v86, v86, v74, v75
  v_fma_f32 v87, v87, v74, v75
  v_fma_f32 v94, v94, v76, v77
  v_fma_f32 v95, v95, v76, v77
  v_fma_f32 v88, v88, v74, v75
  v_fma_f32 v89, v89, v74, v75
  buffer_load_dwordx4 v[38:41], v21, s[12:15], s52 offen
  s_add_u32 s52, s52, 229376
  v_fma_f32 v96, v96, v76, v77
  v_fma_f32 v97, v97, v76, v77
  v_cvt_pk_bf16_f32 v98, v82, v83
  v_cvt_pk_bf16_f32 v102, v90, v91
  v_cvt_pk_bf16_f32 v99, v84, v85
  v_cvt_pk_bf16_f32 v103, v92, v93
  v_cvt_pk_bf16_f32 v100, v86, v87
  v_cvt_pk_bf16_f32 v104, v94, v95
  v_cvt_pk_bf16_f32 v101, v88, v89
  v_cvt_pk_bf16_f32 v105, v96, v97
  ds_write_b128 v24, v[98:101] offset:16384
  ds_write_b128 v24, v[102:105] offset:17408
  s_barrier
  s_waitcnt vmcnt(12) lgkmcnt(2)
  ds_read_b64 v[74:75], v22
  ds_read_b64 v[76:77], v23
  v_add_u32 v22, 512, v22
  v_add_u32 v23, 512, v23
  buffer_load_dwordx4 v[42:45], v20, s[12:15], s52 offen
  v_lshlrev_b32 v82, 16, v50
  v_and_b32 v83, 0xffff0000, v50
  v_lshlrev_b32 v90, 16, v54
  v_and_b32 v91, 0xffff0000, v54
  v_lshlrev_b32 v84, 16, v51
  v_and_b32 v85, 0xffff0000, v51
  v_lshlrev_b32 v92, 16, v55
  v_and_b32 v93, 0xffff0000, v55
  v_lshlrev_b32 v86, 16, v52
  v_and_b32 v87, 0xffff0000, v52
  v_lshlrev_b32 v94, 16, v56
  v_and_b32 v95, 0xffff0000, v56
  v_lshlrev_b32 v88, 16, v53
  v_and_b32 v89, 0xffff0000, v53
  v_lshlrev_b32 v96, 16, v57
  v_and_b32 v97, 0xffff0000, v57
  v_fma_f32 v82, v82, v78, v79
  v_fma_f32 v83, v83, v78, v79
  v_fma_f32 v90, v90, v80, v81
  v_fma_f32 v91, v91, v80, v81
  v_fma_f32 v84, v84, v78, v79
  buffer_load_dwordx4 v[46:49], v21, s[12:15], s52 offen
  s_add_u32 s52, s52, 229376
  v_fma_f32 v85, v85, v78, v79
  v_fma_f32 v92, v92, v80, v81
  v_fma_f32 v93, v93, v80, v81
  v_fma_f32 v86, v86, v78, v79
  v_fma_f32 v87, v87, v78, v79
  v_fma_f32 v94, v94, v80, v81
  v_fma_f32 v95, v95, v80, v81
  v_fma_f32 v88, v88, v78, v79
  v_fma_f32 v89, v89, v78, v79
  v_fma_f32 v96, v96, v80, v81
  v_fma_f32 v97, v97, v80, v81
  v_cvt_pk_bf16_f32 v106, v82, v83
  v_cvt_pk_bf16_f32 v110, v90, v91
  v_cvt_pk_bf16_f32 v107, v84, v85
  v_cvt_pk_bf16_f32 v111, v92, v93
  v_cvt_pk_bf16_f32 v108, v86, v87
  v_cvt_pk_bf16_f32 v112, v94, v95
  v_cvt_pk_bf16_f32 v109, v88, v89
  v_cvt_pk_bf16_f32 v113, v96, v97
  ds_write_b128 v24, v[106:109] offset:24576
  ds_write_b128 v24, v[110:113] offset:25600
  s_waitcnt lgkmcnt(4)
  s_barrier
  s_waitcnt vmcnt(12) lgkmcnt(2)
  ds_read_b64 v[78:79], v22
  ds_read_b64 v[80:81], v23
  v_add_u32 v22, 512, v22
  v_add_u32 v23, 512, v23
  buffer_load_dwordx4 v[50:53], v20, s[12:15], s52 offen
  v_lshlrev_b32 v82, 16, v58
  v_and_b32 v83, 0xffff0000, v58
  v_lshlrev_b32 v90, 16, v62
  v_and_b32 v91, 0xffff0000, v62
  v_lshlrev_b32 v84, 16, v59
  v_and_b32 v85, 0xffff0000, v59
  v_lshlrev_b32 v92, 16, v63
  v_and_b32 v93, 0xffff0000, v63
  v_lshlrev_b32 v86, 16, v60
  v_and_b32 v87, 0xffff0000, v60
  v_lshlrev_b32 v94, 16, v64
  v_and_b32 v95, 0xffff0000, v64
  v_lshlrev_b32 v88, 16, v61
  v_and_b32 v89, 0xffff0000, v61
  v_lshlrev_b32 v96, 16, v65
  v_and_b32 v97, 0xffff0000, v65
  v_fma_f32 v82, v82, v74, v75
  v_fma_f32 v83, v83, v74, v75
  v_fma_f32 v90, v90, v76, v77
  v_fma_f32 v91, v91, v76, v77
  v_fma_f32 v84, v84, v74, v75
  buffer_load_dwordx4 v[54:57], v21, s[12:15], s52 offen
  s_add_u32 s52, s52, 229376
  v_fma_f32 v85, v85, v74, v75
  v_fma_f32 v92, v92, v76, v77
  v_fma_f32 v93, v93, v76, v77
  v_fma_f32 v86, v86, v74, v75
  v_fma_f32 v87, v87, v74, v75
  v_fma_f32 v94, v94, v76, v77
  v_fma_f32 v95, v95, v76, v77
  v_fma_f32 v88, v88, v74, v75
  v_fma_f32 v89, v89, v74, v75
  v_fma_f32 v96, v96, v76, v77
  v_fma_f32 v97, v97, v76, v77
  v_cvt_pk_bf16_f32 v98, v82, v83
  v_cvt_pk_bf16_f32 v102, v90, v91
  v_cvt_pk_bf16_f32 v99, v84, v85
  v_cvt_pk_bf16_f32 v103, v92, v93
  v_cvt_pk_bf16_f32 v100, v86, v87
  v_cvt_pk_bf16_f32 v104, v94, v95
  v_cvt_pk_bf16_f32 v101, v88, v89
  v_cvt_pk_bf16_f32 v105, v96, v97
  ds_write_b128 v24, v[98:101] offset:0
  ds_write_b128 v24, v[102:105] offset:1024
  s_waitcnt lgkmcnt(4)
  s_barrier
  s_waitcnt vmcnt(12) lgkmcnt(2)
  ds_read_b64 v[74:75], v22
  ds_read_b64 v[76:77], v23
  v_add_u32 v22, 512, v22
  v_add_u32 v23, 512, v23
  buffer_load_dwordx4 v[58:61], v20, s[12:15], s52 offen
  v_lshlrev_b32 v82, 16, v66
  v_and_b32 v83, 0xffff0000, v66
  v_lshlrev_b32 v90, 16, v70
  v_and_b32 v91, 0xffff0000, v70
  v_lshlrev_b32 v84, 16, v67
  v_and_b32 v85, 0xffff0000, v67
  v_lshlrev_b32 v92, 16, v71
  v_and_b32 v93, 0xffff0000, v71
  v_lshlrev_b32 v86, 16, v68
  v_and_b32 v87, 0xffff0000, v68
  v_lshlrev_b32 v94, 16, v72
  v_and_b32 v95, 0xffff0000, v72
  v_lshlrev_b32 v88, 16, v69
  v_and_b32 v89, 0xffff0000, v69
  v_lshlrev_b32 v96, 16, v73
  v_and_b32 v97, 0xffff0000, v73
  v_fma_f32 v82, v82, v78, v79
  v_fma_f32 v83, v83, v78, v79
  v_fma_f32 v90, v90, v80, v81
  v_fma_f32 v91, v91, v80, v81
  v_fma_f32 v84, v84, v78, v79
  buffer_load_dwordx4 v[62:65], v21, s[12:15], s52 offen
  s_add_u32 s52, s52, 229376
  v_fma_f32 v85, v85, v78, v79
  v_fma_f32 v92, v92, v80, v81
  v_fma_f32 v93, v93, v80, v81
  v_fma_f32 v86, v86, v78, v79
  v_fma_f32 v87, v87, v78, v79
  v_fma_f32 v94, v94, v80, v81
  v_fma_f32 v95, v95, v80, v81
  v_fma_f32 v88, v88, v78, v79
  v_fma_f32 v89, v89, v78, v79
  v_fma_f32 v96, v96, v80, v81
  v_fma_f32 v97, v97, v80, v81
  v_cvt_pk_bf16_f32 v106, v82, v83
  v_cvt_pk_bf16_f32 v110, v90, v91
  v_cvt_pk_bf16_f32 v107, v84, v85
  v_cvt_pk_bf16_f32 v111, v92, v93
  v_cvt_pk_bf16_f32 v108, v86, v87
  v_cvt_pk_bf16_f32 v112, v94, v95
  v_cvt_pk_bf16_f32 v109, v88, v89
  v_cvt_pk_bf16_f32 v113, v96, v97
  ds_write_b128 v24, v[106:109] offset:8192
  ds_write_b128 v24, v[110:113] offset:9216
  s_waitcnt lgkmcnt(4)
  s_barrier
  s_waitcnt vmcnt(8) lgkmcnt(2)
  ds_read_b64 v[78:79], v22
  ds_read_b64 v[80:81], v23
  v_add_u32 v22, 512, v22
  v_add_u32 v23, 512, v23
  buffer_load_dwordx4 v[66:69], v20, s[12:15], s52 offen
  v_lshlrev_b32 v82, 16, v26
  v_and_b32 v83, 0xffff0000, v26
  v_lshlrev_b32 v90, 16, v30
  v_and_b32 v91, 0xffff0000, v30
  v_lshlrev_b32 v84, 16, v27
  v_and_b32 v85, 0xffff0000, v27
  v_lshlrev_b32 v92, 16, v31
  v_and_b32 v93, 0xffff0000, v31
  v_lshlrev_b32 v86, 16, v28
  v_and_b32 v87, 0xffff0000, v28
  v_lshlrev_b32 v94, 16, v32
  v_and_b32 v95, 0xffff0000, v32
  v_lshlrev_b32 v88, 16, v29
  v_and_b32 v89, 0xffff0000, v29
  v_lshlrev_b32 v96, 16, v33
  v_and_b32 v97, 0xffff0000, v33
  v_fma_f32 v82, v82, v74, v75
  v_fma_f32 v83, v83, v74, v75
  v_fma_f32 v90, v90, v76, v77
  v_fma_f32 v91, v91, v76, v77
  v_fma_f32 v84, v84, v74, v75
  buffer_load_dwordx4 v[70:73], v21, s[12:15], s52 offen
  s_add_u32 s52, s52, 229376
  v_fma_f32 v85, v85, v74, v75
  v_fma_f32 v92, v92, v76, v77
  v_fma_f32 v93, v93, v76, v77
  v_fma_f32 v86, v86, v74, v75
  v_fma_f32 v87, v87, v74, v75
  v_fma_f32 v94, v94, v76, v77
  v_fma_f32 v95, v95, v76, v77
  v_fma_f32 v88, v88, v74, v75
  v_fma_f32 v89, v89, v74, v75
  v_fma_f32 v96, v96, v76, v77
  v_fma_f32 v97, v97, v76, v77
  v_cvt_pk_bf16_f32 v98, v82, v83
  v_cvt_pk_bf16_f32 v102, v90, v91
  v_cvt_pk_bf16_f32 v99, v84, v85
  v_cvt_pk_bf16_f32 v103, v92, v93
  v_cvt_pk_bf16_f32 v100, v86, v87
  v_cvt_pk_bf16_f32 v104, v94, v95
  v_cvt_pk_bf16_f32 v101, v88, v89
  v_cvt_pk_bf16_f32 v105, v96, v97
  ds_write_b128 v24, v[98:101] offset:16384
  ds_write_b128 v24, v[102:105] offset:17408
  s_waitcnt lgkmcnt(4)
  s_barrier
  s_waitcnt vmcnt(8) lgkmcnt(2)
  ds_read_b64 v[74:75], v22
  ds_read_b64 v[76:77], v23
  v_add_u32 v22, 512, v22
  v_add_u32 v23, 512, v23
  buffer_load_dwordx4 v[26:29], v20, s[12:15], s52 offen
  v_lshlrev_b32 v82, 16, v34
  v_and_b32 v83, 0xffff0000, v34
  v_lshlrev_b32 v90, 16, v38
  v_and_b32 v91, 0xffff0000, v38
  v_lshlrev_b32 v84, 16, v35
  v_and_b32 v85, 0xffff0000, v35
  v_lshlrev_b32 v92, 16, v39
  v_and_b32 v93, 0xffff0000, v39
  v_lshlrev_b32 v86, 16, v36
  v_and_b32 v87, 0xffff0000, v36
  v_lshlrev_b32 v94, 16, v40
  v_and_b32 v95, 0xffff0000, v40
  v_lshlrev_b32 v88, 16, v37
  v_and_b32 v89, 0xffff0000, v37
  v_lshlrev_b32 v96, 16, v41
  v_and_b32 v97, 0xffff0000, v41
  v_fma_f32 v82, v82, v78, v79
  v_fma_f32 v83, v83, v78, v79
  v_fma_f32 v90, v90, v80, v81
  v_fma_f32 v91, v91, v80, v81
  v_fma_f32 v84, v84, v78, v79
  buffer_load_dwordx4 v[30:33], v21, s[12:15], s52 offen
  s_add_u32 s52, s52, 229376
  v_fma_f32 v85, v85, v78, v79
  v_fma_f32 v92, v92, v80, v81
  v_fma_f32 v93, v93, v80, v81
  v_fma_f32 v86, v86, v78, v79
  v_fma_f32 v87, v87, v78, v79
  v_fma_f32 v94, v94, v80, v81
  v_fma_f32 v95, v95, v80, v81
  v_fma_f32 v88, v88, v78, v79
  v_fma_f32 v89, v89, v78, v79
  v_fma_f32 v96, v96, v80, v81
  v_fma_f32 v97, v97, v80, v81
  v_cvt_pk_bf16_f32 v106, v82, v83
  v_cvt_pk_bf16_f32 v110, v90, v91
  v_cvt_pk_bf16_f32 v107, v84, v85
  v_cvt_pk_bf16_f32 v111, v92, v93
  v_cvt_pk_bf16_f32 v108, v86, v87
  v_cvt_pk_bf16_f32 v112, v94, v95
  v_cvt_pk_bf16_f32 v109, v88, v89
  v_cvt_pk_bf16_f32 v113, v96, v97
  ds_write_b128 v24, v[106:109] offset:24576
  ds_write_b128 v24, v[110:113] offset:25600
  s_waitcnt lgkmcnt(4)
  s_barrier
  s_waitcnt vmcnt(8) lgkmcnt(2)
  ds_read_b64 v[78:79], v22
  ds_read_b64 v[80:81], v23
  v_add_u32 v22, 512, v22
  v_add_u32 v23, 512, v23
  buffer_load_dwordx4 v[34:37], v20, s[12:15], s52 offen
  v_lshlrev_b32 v82, 16, v42
  v_and_b32 v83, 0xffff0000, v42
  v_lshlrev_b32 v90, 16, v46
  v_and_b32 v91, 0xffff0000, v46
  v_lshlrev_b32 v84, 16, v43
  v_and_b32 v85, 0xffff0000, v43
  v_lshlrev_b32 v92, 16, v47
  v_and_b32 v93, 0xffff0000, v47
  v_lshlrev_b32 v86, 16, v44
  v_and_b32 v87, 0xffff0000, v44
  v_lshlrev_b32 v94, 16, v48
  v_and_b32 v95, 0xffff0000, v48
  v_lshlrev_b32 v88, 16, v45
  v_and_b32 v89, 0xffff0000, v45
  v_lshlrev_b32 v96, 16, v49
  v_and_b32 v97, 0xffff0000, v49
  v_fma_f32 v82, v82, v74, v75
  v_fma_f32 v83, v83, v74, v75
  v_fma_f32 v90, v90, v76, v77
  v_fma_f32 v91, v91, v76, v77
  v_fma_f32 v84, v84, v74, v75
  buffer_load_dwordx4 v[38:41], v21, s[12:15], s52 offen
  s_add_u32 s52, s52, 229376
  v_fma_f32 v85, v85, v74, v75
  v_fma_f32 v92, v92, v76, v77
  v_fma_f32 v93, v93, v76, v77
  v_fma_f32 v86, v86, v74, v75
  v_fma_f32 v87, v87, v74, v75
  v_fma_f32 v94, v94, v76, v77
  v_fma_f32 v95, v95, v76, v77
  v_fma_f32 v88, v88, v74, v75
  v_fma_f32 v89, v89, v74, v75
  v_fma_f32 v96, v96, v76, v77
  v_fma_f32 v97, v97, v76, v77
  v_cvt_pk_bf16_f32 v98, v82, v83
  v_cvt_pk_bf16_f32 v102, v90, v91
  v_cvt_pk_bf16_f32 v99, v84, v85
  v_cvt_pk_bf16_f32 v103, v92, v93
  v_cvt_pk_bf16_f32 v100, v86, v87
  v_cvt_pk_bf16_f32 v104, v94, v95
  v_cvt_pk_bf16_f32 v101, v88, v89
  v_cvt_pk_bf16_f32 v105, v96, v97
  ds_write_b128 v24, v[98:101] offset:0
  ds_write_b128 v24, v[102:105] offset:1024
  s_waitcnt lgkmcnt(4)
  s_barrier
  s_waitcnt vmcnt(8) lgkmcnt(2)
  ds_read_b64 v[74:75], v22
  ds_read_b64 v[76:77], v23
  v_add_u32 v22, 512, v22
  v_add_u32 v23, 512, v23
  buffer_load_dwordx4 v[42:45], v20, s[12:15], s52 offen
  v_lshlrev_b32 v82, 16, v50
  v_and_b32 v83, 0xffff0000, v50
  v_lshlrev_b32 v90, 16, v54
  v_and_b32 v91, 0xffff0000, v54
  v_lshlrev_b32 v84, 16, v51
  v_and_b32 v85, 0xffff0000, v51
  v_lshlrev_b32 v92, 16, v55
  v_and_b32 v93, 0xffff0000, v55
  v_lshlrev_b32 v86, 16, v52
  v_and_b32 v87, 0xffff0000, v52
  v_lshlrev_b32 v94, 16, v56
  v_and_b32 v95, 0xffff0000, v56
  v_lshlrev_b32 v88, 16, v53
  v_and_b32 v89, 0xffff0000, v53
  v_lshlrev_b32 v96, 16, v57
  v_and_b32 v97, 0xffff0000, v57
  v_fma_f32 v82, v82, v78, v79
  v_fma_f32 v83, v83, v78, v79
  v_fma_f32 v90, v90, v80, v81
  v_fma_f32 v91, v91, v80, v81
  v_fma_f32 v84, v84, v78, v79
  buffer_load_dwordx4 v[46:49], v21, s[12:15], s52 offen
  s_add_u32 s52, s52, 229376
  v_fma_f32 v85, v85, v78, v79
  v_fma_f32 v92, v92, v80, v81
  v_fma_f32 v93, v93, v80, v81
  v_fma_f32 v86, v86, v78, v79
  v_fma_f32 v87, v87, v78, v79
  v_fma_f32 v94, v94, v80, v81
  v_fma_f32 v95, v95, v80, v81
  v_fma_f32 v88, v88, v78, v79
  v_fma_f32 v89, v89, v78, v79
  v_fma_f32 v96, v96, v80, v81
  v_fma_f32 v97, v97, v80, v81
  v_cvt_pk_bf16_f32 v106, v82, v83
  v_cvt_pk_bf16_f32 v110, v90, v91
  v_cvt_pk_bf16_f32 v107, v84, v85
  v_cvt_pk_bf16_f32 v111, v92, v93
  v_cvt_pk_bf16_f32 v108, v86, v87
  v_cvt_pk_bf16_f32 v112, v94, v95
  v_cvt_pk_bf16_f32 v109, v88, v89
  v_cvt_pk_bf16_f32 v113, v96, v97
  ds_write_b128 v24, v[106:109] offset:8192
  ds_write_b128 v24, v[110:113] offset:9216
  s_waitcnt lgkmcnt(4)
  s_barrier
  s_waitcnt vmcnt(8) lgkmcnt(2)
  ds_read_b64 v[78:79], v22
  ds_read_b64 v[80:81], v23
  v_add_u32 v22, 512, v22
  v_add_u32 v23, 512, v23
  buffer_load_dwordx4 v[50:53], v20, s[12:15], s52 offen
  v_lshlrev_b32 v82, 16, v58
  v_and_b32 v83, 0xffff0000, v58
  v_lshlrev_b32 v90, 16, v62
  v_and_b32 v91, 0xffff0000, v62
  v_lshlrev_b32 v84, 16, v59
  v_and_b32 v85, 0xffff0000, v59
  v_lshlrev_b32 v92, 16, v63
  v_and_b32 v93, 0xffff0000, v63
  v_lshlrev_b32 v86, 16, v60
  v_and_b32 v87, 0xffff0000, v60
  v_lshlrev_b32 v94, 16, v64
  v_and_b32 v95, 0xffff0000, v64
  v_lshlrev_b32 v88, 16, v61
  v_and_b32 v89, 0xffff0000, v61
  v_lshlrev_b32 v96, 16, v65
  v_and_b32 v97, 0xffff0000, v65
  v_fma_f32 v82, v82, v74, v75
  v_fma_f32 v83, v83, v74, v75
  v_fma_f32 v90, v90, v76, v77
  v_fma_f32 v91, v91, v76, v77
  v_fma_f32 v84, v84, v74, v75
  buffer_load_dwordx4 v[54:57], v21, s[12:15], s52 offen
  s_add_u32 s52, s52, 229376
  v_fma_f32 v85, v85, v74, v75
  v_fma_f32 v92, v92, v76, v77
  v_fma_f32 v93, v93, v76, v77
  v_fma_f32 v86, v86, v74, v75
  v_fma_f32 v87, v87, v74, v75
  v_fma_f32 v94, v94, v76, v77
  v_fma_f32 v95, v95, v76, v77
  v_fma_f32 v88, v88, v74, v75
  v_fma_f32 v89, v89, v74, v75
  v_fma_f32 v96, v96, v76, v77
  v_fma_f32 v97, v97, v76, v77
  v_cvt_pk_bf16_f32 v98, v82, v83
  v_cvt_pk_bf16_f32 v102, v90, v91
  v_cvt_pk_bf16_f32 v99, v84, v85
  v_cvt_pk_bf16_f32 v103, v92, v93
  v_cvt_pk_bf16_f32 v100, v86, v87
  v_cvt_pk_bf16_f32 v104, v94, v95
  v_cvt_pk_bf16_f32 v101, v88, v89
  v_cvt_pk_bf16_f32 v105, v96, v97
  ds_write_b128 v24, v[98:101] offset:16384
  ds_write_b128 v24, v[102:105] offset:17408
  s_waitcnt lgkmcnt(4)
  s_barrier
  s_waitcnt vmcnt(8) lgkmcnt(2)
  ds_read_b64 v[74:75], v22
  ds_read_b64 v[76:77], v23
  v_add_u32 v22, 512, v22
  v_add_u32 v23, 512, v23
  buffer_load_dwordx4 v[58:61], v20, s[12:15], s52 offen
  v_lshlrev_b32 v82, 16, v66
  v_and_b32 v83, 0xffff0000, v66
  v_lshlrev_b32 v90, 16, v70
  v_and_b32 v91, 0xffff0000, v70
  v_lshlrev_b32 v84, 16, v67
  v_and_b32 v85, 0xffff0000, v67
  v_lshlrev_b32 v92, 16, v71
  v_and_b32 v93, 0xffff0000, v71
  v_lshlrev_b32 v86, 16, v68
  v_and_b32 v87, 0xffff0000, v68
  v_lshlrev_b32 v94, 16, v72
  v_and_b32 v95, 0xffff0000, v72
  v_lshlrev_b32 v88, 16, v69
  v_and_b32 v89, 0xffff0000, v69
  v_lshlrev_b32 v96, 16, v73
  v_and_b32 v97, 0xffff0000, v73
  v_fma_f32 v82, v82, v78, v79
  v_fma_f32 v83, v83, v78, v79
  v_fma_f32 v90, v90, v80, v81
  v_fma_f32 v91, v91, v80, v81
  v_fma_f32 v84, v84, v78, v79
  buffer_load_dwordx4 v[62:65], v21, s[12:15], s52 offen
  s_add_u32 s52, s52, 229376
  v_fma_f32 v85, v85, v78, v79
  v_fma_f32 v92, v92, v80, v81
  v_fma_f32 v93, v93, v80, v81
  v_fma_f32 v86, v86, v78, v79
  v_fma_f32 v87, v87, v78, v79
  v_fma_f32 v94, v94, v80, v81
  v_fma_f32 v95, v95, v80, v81
  v_fma_f32 v88, v88, v78, v79
  v_fma_f32 v89, v89, v78, v79
  v_fma_f32 v96, v96, v80, v81
  v_fma_f32 v97, v97, v80, v81
  v_cvt_pk_bf16_f32 v106, v82, v83
  v_cvt_pk_bf16_f32 v110, v90, v91
  v_cvt_pk_bf16_f32 v107, v84, v85
  v_cvt_pk_bf16_f32 v111, v92, v93
  v_cvt_pk_bf16_f32 v108, v86, v87
  v_cvt_pk_bf16_f32 v112, v94, v95
  v_cvt_pk_bf16_f32 v109, v88, v89
  v_cvt_pk_bf16_f32 v113, v96, v97
  ds_write_b128 v24, v[106:109] offset:24576
  ds_write_b128 v24, v[110:113] offset:25600
  s_waitcnt lgkmcnt(4)
  s_barrier
  s_waitcnt vmcnt(8) lgkmcnt(2)
  ds_read_b64 v[78:79], v22
  ds_read_b64 v[80:81], v23
  v_add_u32 v22, 512, v22
  v_add_u32 v23, 512, v23
  buffer_load_dwordx4 v[66:69], v20, s[12:15], s52 offen
  v_lshlrev_b32 v82, 16, v26
  v_and_b32 v83, 0xffff0000, v26
  v_lshlrev_b32 v90, 16, v30
  v_and_b32 v91, 0xffff0000, v30
  v_lshlrev_b32 v84, 16, v27
  v_and_b32 v85, 0xffff0000, v27
  v_lshlrev_b32 v92, 16, v31
  v_and_b32 v93, 0xffff0000, v31
  v_lshlrev_b32 v86, 16, v28
  v_and_b32 v87, 0xffff0000, v28
  v_lshlrev_b32 v94, 16, v32
  v_and_b32 v95, 0xffff0000, v32
  v_lshlrev_b32 v88, 16, v29
  v_and_b32 v89, 0xffff0000, v29
  v_lshlrev_b32 v96, 16, v33
  v_and_b32 v97, 0xffff0000, v33
  v_fma_f32 v82, v82, v74, v75
  v_fma_f32 v83, v83, v74, v75
  v_fma_f32 v90, v90, v76, v77
  v_fma_f32 v91, v91, v76, v77
  v_fma_f32 v84, v84, v74, v75
  buffer_load_dwordx4 v[70:73], v21, s[12:15], s52 offen
  s_add_u32 s52, s52, 229376
  v_fma_f32 v85, v85, v74, v75
  v_fma_f32 v92, v92, v76, v77
  v_fma_f32 v93, v93, v76, v77
  v_fma_f32 v86, v86, v74, v75
  v_fma_f32 v87, v87, v74, v75
  v_fma_f32 v94, v94, v76, v77
  v_fma_f32 v95, v95, v76, v77
  v_fma_f32 v88, v88, v74, v75
  v_fma_f32 v89, v89, v74, v75
  v_fma_f32 v96, v96, v76, v77
  v_fma_f32 v97, v97, v76, v77
  v_cvt_pk_bf16_f32 v98, v82, v83
  v_cvt_pk_bf16_f32 v102, v90, v91
  v_cvt_pk_bf16_f32 v99, v84, v85
  v_cvt_pk_bf16_f32 v103, v92, v93
  v_cvt_pk_bf16_f32 v100, v86, v87
  v_cvt_pk_bf16_f32 v104, v94, v95
  v_cvt_pk_bf16_f32 v101, v88, v89
  v_cvt_pk_bf16_f32 v105, v96, v97
  ds_write_b128 v24, v[98:101] offset:0
  ds_write_b128 v24, v[102:105] offset:1024
  s_waitcnt lgkmcnt(4)
  s_barrier
  s_waitcnt vmcnt(8) lgkmcnt(2)
  ds_read_b64 v[74:75], v22
  ds_read_b64 v[76:77], v23
  v_add_u32 v22, 512, v22
  v_add_u32 v23, 512, v23
  buffer_load_dwordx4 v[26:29], v20, s[12:15], s52 offen
  v_lshlrev_b32 v82, 16, v34
  v_and_b32 v83, 0xffff0000, v34
  v_lshlrev_b32 v90, 16, v38
  v_and_b32 v91, 0xffff0000, v38
  v_lshlrev_b32 v84, 16, v35
  v_and_b32 v85, 0xffff0000, v35
  v_lshlrev_b32 v92, 16, v39
  v_and_b32 v93, 0xffff0000, v39
  v_lshlrev_b32 v86, 16, v36
  v_and_b32 v87, 0xffff0000, v36
  v_lshlrev_b32 v94, 16, v40
  v_and_b32 v95, 0xffff0000, v40
  v_lshlrev_b32 v88, 16, v37
  v_and_b32 v89, 0xffff0000, v37
  v_lshlrev_b32 v96, 16, v41
  v_and_b32 v97, 0xffff0000, v41
  v_fma_f32 v82, v82, v78, v79
  v_fma_f32 v83, v83, v78, v79
  v_fma_f32 v90, v90, v80, v81
  v_fma_f32 v91, v91, v80, v81
  v_fma_f32 v84, v84, v78, v79
  buffer_load_dwordx4 v[30:33], v21, s[12:15], s52 offen
  s_add_u32 s52, s52, 229376
  v_fma_f32 v85, v85, v78, v79
  v_fma_f32 v92, v92, v80, v81
  v_fma_f32 v93, v93, v80, v81
  v_fma_f32 v86, v86, v78, v79
  v_fma_f32 v87, v87, v78, v79
  v_fma_f32 v94, v94, v80, v81
  v_fma_f32 v95, v95, v80, v81
  v_fma_f32 v88, v88, v78, v79
  v_fma_f32 v89, v89, v78, v79
  v_fma_f32 v96, v96, v80, v81
  v_fma_f32 v97, v97, v80, v81
  v_cvt_pk_bf16_f32 v106, v82, v83
  v_cvt_pk_bf16_f32 v110, v90, v91
  v_cvt_pk_bf16_f32 v107, v84, v85
  v_cvt_pk_bf16_f32 v111, v92, v93
  v_cvt_pk_bf16_f32 v108, v86, v87
  v_cvt_pk_bf16_f32 v112, v94, v95
  v_cvt_pk_bf16_f32 v109, v88, v89
  v_cvt_pk_bf16_f32 v113, v96, v97
  ds_write_b128 v24, v[106:109] offset:8192
  ds_write_b128 v24, v[110:113] offset:9216
  s_waitcnt lgkmcnt(4)
  s_barrier
  s_waitcnt vmcnt(8) lgkmcnt(2)
  ds_read_b64 v[78:79], v22
  ds_read_b64 v[80:81], v23
  v_add_u32 v22, 512, v22
  v_add_u32 v23, 512, v23
  buffer_load_dwordx4 v[34:37], v20, s[12:15], s52 offen
  v_lshlrev_b32 v82, 16, v42
  v_and_b32 v83, 0xffff0000, v42
  v_lshlrev_b32 v90, 16, v46
  v_and_b32 v91, 0xffff0000, v46
  v_lshlrev_b32 v84, 16, v43
  v_and_b32 v85, 0xffff0000, v43
  v_lshlrev_b32 v92, 16, v47
  v_and_b32 v93, 0xffff0000, v47
  v_lshlrev_b32 v86, 16, v44
  v_and_b32 v87, 0xffff0000, v44
  v_lshlrev_b32 v94, 16, v48
  v_and_b32 v95, 0xffff0000, v48
  v_lshlrev_b32 v88, 16, v45
  v_and_b32 v89, 0xffff0000, v45
  v_lshlrev_b32 v96, 16, v49
  v_and_b32 v97, 0xffff0000, v49
  v_fma_f32 v82, v82, v74, v75
  v_fma_f32 v83, v83, v74, v75
  v_fma_f32 v90, v90, v76, v77
  v_fma_f32 v91, v91, v76, v77
  v_fma_f32 v84, v84, v74, v75
  buffer_load_dwordx4 v[38:41], v21, s[12:15], s52 offen
  s_add_u32 s52, s52, 229376
  v_fma_f32 v85, v85, v74, v75
  v_fma_f32 v92, v92, v76, v77
  v_fma_f32 v93, v93, v76, v77
  v_fma_f32 v86, v86, v74, v75
  v_fma_f32 v87, v87, v74, v75
  v_fma_f32 v94, v94, v76, v77
  v_fma_f32 v95, v95, v76, v77
  v_fma_f32 v88, v88, v74, v75
  v_fma_f32 v89, v89, v74, v75
  v_fma_f32 v96, v96, v76, v77
  v_fma_f32 v97, v97, v76, v77
  v_cvt_pk_bf16_f32 v98, v82, v83
  v_cvt_pk_bf16_f32 v102, v90, v91
  v_cvt_pk_bf16_f32 v99, v84, v85
  v_cvt_pk_bf16_f32 v103, v92, v93
  v_cvt_pk_bf16_f32 v100, v86, v87
  v_cvt_pk_bf16_f32 v104, v94, v95
  v_cvt_pk_bf16_f32 v101, v88, v89
  v_cvt_pk_bf16_f32 v105, v96, v97
  ds_write_b128 v24, v[98:101] offset:16384
  ds_write_b128 v24, v[102:105] offset:17408
  s_waitcnt lgkmcnt(4)
  s_barrier
  s_waitcnt vmcnt(8) lgkmcnt(2)
  ds_read_b64 v[74:75], v22
  ds_read_b64 v[76:77], v23
  v_add_u32 v22, 512, v22
  v_add_u32 v23, 512, v23
  buffer_load_dwordx4 v[42:45], v20, s[12:15], s52 offen
  v_lshlrev_b32 v82, 16, v50
  v_and_b32 v83, 0xffff0000, v50
  v_lshlrev_b32 v90, 16, v54
  v_and_b32 v91, 0xffff0000, v54
  v_lshlrev_b32 v84, 16, v51
  v_and_b32 v85, 0xffff0000, v51
  v_lshlrev_b32 v92, 16, v55
  v_and_b32 v93, 0xffff0000, v55
  v_lshlrev_b32 v86, 16, v52
  v_and_b32 v87, 0xffff0000, v52
  v_lshlrev_b32 v94, 16, v56
  v_and_b32 v95, 0xffff0000, v56
  v_lshlrev_b32 v88, 16, v53
  v_and_b32 v89, 0xffff0000, v53
  v_lshlrev_b32 v96, 16, v57
  v_and_b32 v97, 0xffff0000, v57
  v_fma_f32 v82, v82, v78, v79
  v_fma_f32 v83, v83, v78, v79
  v_fma_f32 v90, v90, v80, v81
  v_fma_f32 v91, v91, v80, v81
  v_fma_f32 v84, v84, v78, v79
  buffer_load_dwordx4 v[46:49], v21, s[12:15], s52 offen
  s_add_u32 s52, s52, 229376
  v_fma_f32 v85, v85, v78, v79
  v_fma_f32 v92, v92, v80, v81
  v_fma_f32 v93, v93, v80, v81
  v_fma_f32 v86, v86, v78, v79
  v_fma_f32 v87, v87, v78, v79
  v_fma_f32 v94, v94, v80, v81
  v_fma_f32 v95, v95, v80, v81
  v_fma_f32 v88, v88, v78, v79
  v_fma_f32 v89, v89, v78, v79
  v_fma_f32 v96, v96, v80, v81
  v_fma_f32 v97, v97, v80, v81
  v_cvt_pk_bf16_f32 v106, v82, v83
  v_cvt_pk_bf16_f32 v110, v90, v91
  v_cvt_pk_bf16_f32 v107, v84, v85
  v_cvt_pk_bf16_f32 v111, v92, v93
  v_cvt_pk_bf16_f32 v108, v86, v87
  v_cvt_pk_bf16_f32 v112, v94, v95
  v_cvt_pk_bf16_f32 v109, v88, v89
  v_cvt_pk_bf16_f32 v113, v96, v97
  ds_write_b128 v24, v[106:109] offset:24576
  ds_write_b128 v24, v[110:113] offset:25600
  s_waitcnt lgkmcnt(4)
  s_barrier
  s_waitcnt vmcnt(8) lgkmcnt(2)
  ds_read_b64 v[78:79], v22
  ds_read_b64 v[80:81], v23
  v_add_u32 v22, 512, v22
  v_add_u32 v23, 512, v23
  buffer_load_dwordx4 v[50:53], v20, s[12:15], s52 offen
  v_lshlrev_b32 v82, 16, v58
  v_and_b32 v83, 0xffff0000, v58
  v_lshlrev_b32 v90, 16, v62
  v_and_b32 v91, 0xffff0000, v62
  v_lshlrev_b32 v84, 16, v59
  v_and_b32 v85, 0xffff0000, v59
  v_lshlrev_b32 v92, 16, v63
  v_and_b32 v93, 0xffff0000, v63
  v_lshlrev_b32 v86, 16, v60
  v_and_b32 v87, 0xffff0000, v60
  v_lshlrev_b32 v94, 16, v64
  v_and_b32 v95, 0xffff0000, v64
  v_lshlrev_b32 v88, 16, v61
  v_and_b32 v89, 0xffff0000, v61
  v_lshlrev_b32 v96, 16, v65
  v_and_b32 v97, 0xffff0000, v65
  v_fma_f32 v82, v82, v74, v75
  v_fma_f32 v83, v83, v74, v75
  v_fma_f32 v90, v90, v76, v77
  v_fma_f32 v91, v91, v76, v77
  v_fma_f32 v84, v84, v74, v75
  buffer_load_dwordx4 v[54:57], v21, s[12:15], s52 offen
  s_add_u32 s52, s52, 229376
  v_fma_f32 v85, v85, v74, v75
  v_fma_f32 v92, v92, v76, v77
  v_fma_f32 v93, v93, v76, v77
  v_fma_f32 v86, v86, v74, v75
  v_fma_f32 v87, v87, v74, v75
  v_fma_f32 v94, v94, v76, v77
  v_fma_f32 v95, v95, v76, v77
  v_fma_f32 v88, v88, v74, v75
  v_fma_f32 v89, v89, v74, v75
  v_fma_f32 v96, v96, v76, v77
  v_fma_f32 v97, v97, v76, v77
  v_cvt_pk_bf16_f32 v98, v82, v83
  v_cvt_pk_bf16_f32 v102, v90, v91
  v_cvt_pk_bf16_f32 v99, v84, v85
  v_cvt_pk_bf16_f32 v103, v92, v93
  v_cvt_pk_bf16_f32 v100, v86, v87
  v_cvt_pk_bf16_f32 v104, v94, v95
  v_cvt_pk_bf16_f32 v101, v88, v89
  v_cvt_pk_bf16_f32 v105, v96, v97
  ds_write_b128 v24, v[98:101] offset:0
  ds_write_b128 v24, v[102:105] offset:1024
  s_waitcnt lgkmcnt(4)
  s_barrier
  s_waitcnt vmcnt(8) lgkmcnt(2)
  ds_read_b64 v[74:75], v22
  ds_read_b64 v[76:77], v23
  v_add_u32 v22, 512, v22
  v_add_u32 v23, 512, v23
  buffer_load_dwordx4 v[58:61], v20, s[12:15], s52 offen
  v_lshlrev_b32 v82, 16, v66
  v_and_b32 v83, 0xffff0000, v66
  v_lshlrev_b32 v90, 16, v70
  v_and_b32 v91, 0xffff0000, v70
  v_lshlrev_b32 v84, 16, v67
  v_and_b32 v85, 0xffff0000, v67
  v_lshlrev_b32 v92, 16, v71
  v_and_b32 v93, 0xffff0000, v71
  v_lshlrev_b32 v86, 16, v68
  v_and_b32 v87, 0xffff0000, v68
  v_lshlrev_b32 v94, 16, v72
  v_and_b32 v95, 0xffff0000, v72
  v_lshlrev_b32 v88, 16, v69
  v_and_b32 v89, 0xffff0000, v69
  v_lshlrev_b32 v96, 16, v73
  v_and_b32 v97, 0xffff0000, v73
  v_fma_f32 v82, v82, v78, v79
  v_fma_f32 v83, v83, v78, v79
  v_fma_f32 v90, v90, v80, v81
  v_fma_f32 v91, v91, v80, v81
  v_fma_f32 v84, v84, v78, v79
  buffer_load_dwordx4 v[62:65], v21, s[12:15], s52 offen
  s_add_u32 s52, s52, 229376
  v_fma_f32 v85, v85, v78, v79
  v_fma_f32 v92, v92, v80, v81
  v_fma_f32 v93, v93, v80, v81
  v_fma_f32 v86, v86, v78, v79
  v_fma_f32 v87, v87, v78, v79
  v_fma_f32 v94, v94, v80, v81
  v_fma_f32 v95, v95, v80, v81
  v_fma_f32 v88, v88, v78, v79
  v_fma_f32 v89, v89, v78, v79
  v_fma_f32 v96, v96, v80, v81
  v_fma_f32 v97, v97, v80, v81
  v_cvt_pk_bf16_f32 v106, v82, v83
  v_cvt_pk_bf16_f32 v110, v90, v91
  v_cvt_pk_bf16_f32 v107, v84, v85
  v_cvt_pk_bf16_f32 v111, v92, v93
  v_cvt_pk_bf16_f32 v108, v86, v87
  v_cvt_pk_bf16_f32 v112, v94, v95
  v_cvt_pk_bf16_f32 v109, v88, v89
  v_cvt_pk_bf16_f32 v113, v96, v97
  ds_write_b128 v24, v[106:109] offset:8192
  ds_write_b128 v24, v[110:113] offset:9216
  s_waitcnt lgkmcnt(4)
  s_barrier
  s_waitcnt vmcnt(8) lgkmcnt(2)
  ds_read_b64 v[78:79], v22
  ds_read_b64 v[80:81], v23
  v_add_u32 v22, 512, v22
  v_add_u32 v23, 512, v23
  buffer_load_dwordx4 v[66:69], v20, s[12:15], s52 offen
  v_lshlrev_b32 v82, 16, v26
  v_and_b32 v83, 0xffff0000, v26
  v_lshlrev_b32 v90, 16, v30
  v_and_b32 v91, 0xffff0000, v30
  v_lshlrev_b32 v84, 16, v27
  v_and_b32 v85, 0xffff0000, v27
  v_lshlrev_b32 v92, 16, v31
  v_and_b32 v93, 0xffff0000, v31
  v_lshlrev_b32 v86, 16, v28
  v_and_b32 v87, 0xffff0000, v28
  v_lshlrev_b32 v94, 16, v32
  v_and_b32 v95, 0xffff0000, v32
  v_lshlrev_b32 v88, 16, v29
  v_and_b32 v89, 0xffff0000, v29
  v_lshlrev_b32 v96, 16, v33
  v_and_b32 v97, 0xffff0000, v33
  v_fma_f32 v82, v82, v74, v75
  v_fma_f32 v83, v83, v74, v75
  v_fma_f32 v90, v90, v76, v77
  v_fma_f32 v91, v91, v76, v77
  v_fma_f32 v84, v84, v74, v75
  buffer_load_dwordx4 v[70:73], v21, s[12:15], s52 offen
  s_add_u32 s52, s52, 229376
  v_fma_f32 v85, v85, v74, v75
  v_fma_f32 v92, v92, v76, v77
  v_fma_f32 v93, v93, v76, v77
  v_fma_f32 v86, v86, v74, v75
  v_fma_f32 v87, v87, v74, v75
  v_fma_f32 v94, v94, v76, v77
  v_fma_f32 v95, v95, v76, v77
  v_fma_f32 v88, v88, v74, v75
  v_fma_f32 v89, v89, v74, v75
  v_fma_f32 v96, v96, v76, v77
  v_fma_f32 v97, v97, v76, v77
  v_cvt_pk_bf16_f32 v98, v82, v83
  v_cvt_pk_bf16_f32 v102, v90, v91
  v_cvt_pk_bf16_f32 v99, v84, v85
  v_cvt_pk_bf16_f32 v103, v92, v93
  v_cvt_pk_bf16_f32 v100, v86, v87
  v_cvt_pk_bf16_f32 v104, v94, v95
  v_cvt_pk_bf16_f32 v101, v88, v89
  v_cvt_pk_bf16_f32 v105, v96, v97
  ds_write_b128 v24, v[98:101] offset:16384
  ds_write_b128 v24, v[102:105] offset:17408
  s_waitcnt lgkmcnt(4)
  s_barrier
  s_waitcnt vmcnt(8) lgkmcnt(2)
  ds_read_b64 v[74:75], v22
  ds_read_b64 v[76:77], v23
  v_add_u32 v22, 512, v22
  v_add_u32 v23, 512, v23
  buffer_load_dwordx4 v[26:29], v20, s[12:15], s52 offen
  v_lshlrev_b32 v82, 16, v34
  v_and_b32 v83, 0xffff0000, v34
  v_lshlrev_b32 v90, 16, v38
  v_and_b32 v91, 0xffff0000, v38
  v_lshlrev_b32 v84, 16, v35
  v_and_b32 v85, 0xffff0000, v35
  v_lshlrev_b32 v92, 16, v39
  v_and_b32 v93, 0xffff0000, v39
  v_lshlrev_b32 v86, 16, v36
  v_and_b32 v87, 0xffff0000, v36
  v_lshlrev_b32 v94, 16, v40
  v_and_b32 v95, 0xffff0000, v40
  v_lshlrev_b32 v88, 16, v37
  v_and_b32 v89, 0xffff0000, v37
  v_lshlrev_b32 v96, 16, v41
  v_and_b32 v97, 0xffff0000, v41
  v_fma_f32 v82, v82, v78, v79
  v_fma_f32 v83, v83, v78, v79
  v_fma_f32 v90, v90, v80, v81
  v_fma_f32 v91, v91, v80, v81
  v_fma_f32 v84, v84, v78, v79
  buffer_load_dwordx4 v[30:33], v21, s[12:15], s52 offen
  s_add_u32 s52, s52, 229376
  v_fma_f32 v85, v85, v78, v79
  v_fma_f32 v92, v92, v80, v81
  v_fma_f32 v93, v93, v80, v81
  v_fma_f32 v86, v86, v78, v79
  v_fma_f32 v87, v87, v78, v79
  v_fma_f32 v94, v94, v80, v81
  v_fma_f32 v95, v95, v80, v81
  v_fma_f32 v88, v88, v78, v79
  v_fma_f32 v89, v89, v78, v79
  v_fma_f32 v96, v96, v80, v81
  v_fma_f32 v97, v97, v80, v81
  v_cvt_pk_bf16_f32 v106, v82, v83
  v_cvt_pk_bf16_f32 v110, v90, v91
  v_cvt_pk_bf16_f32 v107, v84, v85
  v_cvt_pk_bf16_f32 v111, v92, v93
  v_cvt_pk_bf16_f32 v108, v86, v87
  v_cvt_pk_bf16_f32 v112, v94, v95
  v_cvt_pk_bf16_f32 v109, v88, v89
  v_cvt_pk_bf16_f32 v113, v96, v97
  ds_write_b128 v24, v[106:109] offset:24576
  ds_write_b128 v24, v[110:113] offset:25600
  s_waitcnt lgkmcnt(4)
  s_barrier
  s_waitcnt vmcnt(8) lgkmcnt(2)
  ds_read_b64 v[78:79], v22
  ds_read_b64 v[80:81], v23
  v_add_u32 v22, 512, v22
  v_add_u32 v23, 512, v23
  buffer_load_dwordx4 v[34:37], v20, s[12:15], s52 offen
  v_lshlrev_b32 v82, 16, v42
  v_and_b32 v83, 0xffff0000, v42
  v_lshlrev_b32 v90, 16, v46
  v_and_b32 v91, 0xffff0000, v46
  v_lshlrev_b32 v84, 16, v43
  v_and_b32 v85, 0xffff0000, v43
  v_lshlrev_b32 v92, 16, v47
  v_and_b32 v93, 0xffff0000, v47
  v_lshlrev_b32 v86, 16, v44
  v_and_b32 v87, 0xffff0000, v44
  v_lshlrev_b32 v94, 16, v48
  v_and_b32 v95, 0xffff0000, v48
  v_lshlrev_b32 v88, 16, v45
  v_and_b32 v89, 0xffff0000, v45
  v_lshlrev_b32 v96, 16, v49
  v_and_b32 v97, 0xffff0000, v49
  v_fma_f32 v82, v82, v74, v75
  v_fma_f32 v83, v83, v74, v75
  v_fma_f32 v90, v90, v76, v77
  v_fma_f32 v91, v91, v76, v77
  v_fma_f32 v84, v84, v74, v75
  buffer_load_dwordx4 v[38:41], v21, s[12:15], s52 offen
  s_add_u32 s52, s52, 229376
  v_fma_f32 v85, v85, v74, v75
  v_fma_f32 v92, v92, v76, v77
  v_fma_f32 v93, v93, v76, v77
  v_fma_f32 v86, v86, v74, v75
  v_fma_f32 v87, v87, v74, v75
  v_fma_f32 v94, v94, v76, v77
  v_fma_f32 v95, v95, v76, v77
  v_fma_f32 v88, v88, v74, v75
  v_fma_f32 v89, v89, v74, v75
  v_fma_f32 v96, v96, v76, v77
  v_fma_f32 v97, v97, v76, v77
  v_cvt_pk_bf16_f32 v98, v82, v83
  v_cvt_pk_bf16_f32 v102, v90, v91
  v_cvt_pk_bf16_f32 v99, v84, v85
  v_cvt_pk_bf16_f32 v103, v92, v93
  v_cvt_pk_bf16_f32 v100, v86, v87
  v_cvt_pk_bf16_f32 v104, v94, v95
  v_cvt_pk_bf16_f32 v101, v88, v89
  v_cvt_pk_bf16_f32 v105, v96, v97
  ds_write_b128 v24, v[98:101] offset:0
  ds_write_b128 v24, v[102:105] offset:1024
  s_waitcnt lgkmcnt(4)
  s_barrier
  s_waitcnt vmcnt(8) lgkmcnt(2)
  ds_read_b64 v[74:75], v22
  ds_read_b64 v[76:77], v23
  v_add_u32 v22, 512, v22
  v_add_u32 v23, 512, v23
  buffer_load_dwordx4 v[42:45], v20, s[12:15], s52 offen
  v_lshlrev_b32 v82, 16, v50
  v_and_b32 v83, 0xffff0000, v50
  v_lshlrev_b32 v90, 16, v54
  v_and_b32 v91, 0xffff0000, v54
  v_lshlrev_b32 v84, 16, v51
  v_and_b32 v85, 0xffff0000, v51
  v_lshlrev_b32 v92, 16, v55
  v_and_b32 v93, 0xffff0000, v55
  v_lshlrev_b32 v86, 16, v52
  v_and_b32 v87, 0xffff0000, v52
  v_lshlrev_b32 v94, 16, v56
  v_and_b32 v95, 0xffff0000, v56
  v_lshlrev_b32 v88, 16, v53
  v_and_b32 v89, 0xffff0000, v53
  v_lshlrev_b32 v96, 16, v57
  v_and_b32 v97, 0xffff0000, v57
  v_fma_f32 v82, v82, v78, v79
  v_fma_f32 v83, v83, v78, v79
  v_fma_f32 v90, v90, v80, v81
  v_fma_f32 v91, v91, v80, v81
  v_fma_f32 v84, v84, v78, v79
  buffer_load_dwordx4 v[46:49], v21, s[12:15], s52 offen
  s_add_u32 s52, s52, 229376
  v_fma_f32 v85, v85, v78, v79
  v_fma_f32 v92, v92, v80, v81
  v_fma_f32 v93, v93, v80, v81
  v_fma_f32 v86, v86, v78, v79
  v_fma_f32 v87, v87, v78, v79
  v_fma_f32 v94, v94, v80, v81
  v_fma_f32 v95, v95, v80, v81
  v_fma_f32 v88, v88, v78, v79
  v_fma_f32 v89, v89, v78, v79
  v_fma_f32 v96, v96, v80, v81
  v_fma_f32 v97, v97, v80, v81
  v_cvt_pk_bf16_f32 v106, v82, v83
  v_cvt_pk_bf16_f32 v110, v90, v91
  v_cvt_pk_bf16_f32 v107, v84, v85
  v_cvt_pk_bf16_f32 v111, v92, v93
  v_cvt_pk_bf16_f32 v108, v86, v87
  v_cvt_pk_bf16_f32 v112, v94, v95
  v_cvt_pk_bf16_f32 v109, v88, v89
  v_cvt_pk_bf16_f32 v113, v96, v97
  ds_write_b128 v24, v[106:109] offset:8192
  ds_write_b128 v24, v[110:113] offset:9216
  s_waitcnt lgkmcnt(4)
  s_barrier
  s_waitcnt vmcnt(8) lgkmcnt(2)
  ds_read_b64 v[78:79], v22
  ds_read_b64 v[80:81], v23
  v_add_u32 v22, 512, v22
  v_add_u32 v23, 512, v23
  buffer_load_dwordx4 v[50:53], v20, s[12:15], s52 offen
  v_lshlrev_b32 v82, 16, v58
  v_and_b32 v83, 0xffff0000, v58
  v_lshlrev_b32 v90, 16, v62
  v_and_b32 v91, 0xffff0000, v62
  v_lshlrev_b32 v84, 16, v59
  v_and_b32 v85, 0xffff0000, v59
  v_lshlrev_b32 v92, 16, v63
  v_and_b32 v93, 0xffff0000, v63
  v_lshlrev_b32 v86, 16, v60
  v_and_b32 v87, 0xffff0000, v60
  v_lshlrev_b32 v94, 16, v64
  v_and_b32 v95, 0xffff0000, v64
  v_lshlrev_b32 v88, 16, v61
  v_and_b32 v89, 0xffff0000, v61
  v_lshlrev_b32 v96, 16, v65
  v_and_b32 v97, 0xffff0000, v65
  v_fma_f32 v82, v82, v74, v75
  v_fma_f32 v83, v83, v74, v75
  v_fma_f32 v90, v90, v76, v77
  v_fma_f32 v91, v91, v76, v77
  v_fma_f32 v84, v84, v74, v75
  buffer_load_dwordx4 v[54:57], v21, s[12:15], s52 offen
  s_add_u32 s52, s52, 229376
  v_fma_f32 v85, v85, v74, v75
  v_fma_f32 v92, v92, v76, v77
  v_fma_f32 v93, v93, v76, v77
  v_fma_f32 v86, v86, v74, v75
  v_fma_f32 v87, v87, v74, v75
  v_fma_f32 v94, v94, v76, v77
  v_fma_f32 v95, v95, v76, v77
  v_fma_f32 v88, v88, v74, v75
  v_fma_f32 v89, v89, v74, v75
  v_fma_f32 v96, v96, v76, v77
  v_fma_f32 v97, v97, v76, v77
  v_cvt_pk_bf16_f32 v98, v82, v83
  v_cvt_pk_bf16_f32 v102, v90, v91
  v_cvt_pk_bf16_f32 v99, v84, v85
  v_cvt_pk_bf16_f32 v103, v92, v93
  v_cvt_pk_bf16_f32 v100, v86, v87
  v_cvt_pk_bf16_f32 v104, v94, v95
  v_cvt_pk_bf16_f32 v101, v88, v89
  v_cvt_pk_bf16_f32 v105, v96, v97
  ds_write_b128 v24, v[98:101] offset:16384
  ds_write_b128 v24, v[102:105] offset:17408
  s_waitcnt lgkmcnt(4)
  s_barrier
  s_waitcnt vmcnt(8) lgkmcnt(2)
  ds_read_b64 v[74:75], v22
  ds_read_b64 v[76:77], v23
  v_add_u32 v22, 512, v22
  v_add_u32 v23, 512, v23
  buffer_load_dwordx4 v[58:61], v20, s[12:15], s52 offen
  v_lshlrev_b32 v82, 16, v66
  v_and_b32 v83, 0xffff0000, v66
  v_lshlrev_b32 v90, 16, v70
  v_and_b32 v91, 0xffff0000, v70
  v_lshlrev_b32 v84, 16, v67
  v_and_b32 v85, 0xffff0000, v67
  v_lshlrev_b32 v92, 16, v71
  v_and_b32 v93, 0xffff0000, v71
  v_lshlrev_b32 v86, 16, v68
  v_and_b32 v87, 0xffff0000, v68
  v_lshlrev_b32 v94, 16, v72
  v_and_b32 v95, 0xffff0000, v72
  v_lshlrev_b32 v88, 16, v69
  v_and_b32 v89, 0xffff0000, v69
  v_lshlrev_b32 v96, 16, v73
  v_and_b32 v97, 0xffff0000, v73
  v_fma_f32 v82, v82, v78, v79
  v_fma_f32 v83, v83, v78, v79
  v_fma_f32 v90, v90, v80, v81
  v_fma_f32 v91, v91, v80, v81
  v_fma_f32 v84, v84, v78, v79
  buffer_load_dwordx4 v[62:65], v21, s[12:15], s52 offen
  s_add_u32 s52, s52, 229376
  v_fma_f32 v85, v85, v78, v79
  v_fma_f32 v92, v92, v80, v81
  v_fma_f32 v93, v93, v80, v81
  v_fma_f32 v86, v86, v78, v79
  v_fma_f32 v87, v87, v78, v79
  v_fma_f32 v94, v94, v80, v81
  v_fma_f32 v95, v95, v80, v81
  v_fma_f32 v88, v88, v78, v79
  v_fma_f32 v89, v89, v78, v79
  v_fma_f32 v96, v96, v80, v81
  v_fma_f32 v97, v97, v80, v81
  v_cvt_pk_bf16_f32 v106, v82, v83
  v_cvt_pk_bf16_f32 v110, v90, v91
  v_cvt_pk_bf16_f32 v107, v84, v85
  v_cvt_pk_bf16_f32 v111, v92, v93
  v_cvt_pk_bf16_f32 v108, v86, v87
  v_cvt_pk_bf16_f32 v112, v94, v95
  v_cvt_pk_bf16_f32 v109, v88, v89
  v_cvt_pk_bf16_f32 v113, v96, v97
  ds_write_b128 v24, v[106:109] offset:24576
  ds_write_b128 v24, v[110:113] offset:25600
  s_waitcnt lgkmcnt(4)
  s_barrier
  s_waitcnt vmcnt(8) lgkmcnt(2)
  ds_read_b64 v[78:79], v22
  ds_read_b64 v[80:81], v23
  v_add_u32 v22, 512, v22
  v_add_u32 v23, 512, v23
  buffer_load_dwordx4 v[66:69], v20, s[12:15], s52 offen
  v_lshlrev_b32 v82, 16, v26
  v_and_b32 v83, 0xffff0000, v26
  v_lshlrev_b32 v90, 16, v30
  v_and_b32 v91, 0xffff0000, v30
  v_lshlrev_b32 v84, 16, v27
  v_and_b32 v85, 0xffff0000, v27
  v_lshlrev_b32 v92, 16, v31
  v_and_b32 v93, 0xffff0000, v31
  v_lshlrev_b32 v86, 16, v28
  v_and_b32 v87, 0xffff0000, v28
  v_lshlrev_b32 v94, 16, v32
  v_and_b32 v95, 0xffff0000, v32
  v_lshlrev_b32 v88, 16, v29
  v_and_b32 v89, 0xffff0000, v29
  v_lshlrev_b32 v96, 16, v33
  v_and_b32 v97, 0xffff0000, v33
  v_fma_f32 v82, v82, v74, v75
  v_fma_f32 v83, v83, v74, v75
  v_fma_f32 v90, v90, v76, v77
  v_fma_f32 v91, v91, v76, v77
  v_fma_f32 v84, v84, v74, v75
  buffer_load_dwordx4 v[70:73], v21, s[12:15], s52 offen
  s_add_u32 s52, s52, 229376
  v_fma_f32 v85, v85, v74, v75
  v_fma_f32 v92, v92, v76, v77
  v_fma_f32 v93, v93, v76, v77
  v_fma_f32 v86, v86, v74, v75
  v_fma_f32 v87, v87, v74, v75
  v_fma_f32 v94, v94, v76, v77
  v_fma_f32 v95, v95, v76, v77
  v_fma_f32 v88, v88, v74, v75
  v_fma_f32 v89, v89, v74, v75
  v_fma_f32 v96, v96, v76, v77
  v_fma_f32 v97, v97, v76, v77
  v_cvt_pk_bf16_f32 v98, v82, v83
  v_cvt_pk_bf16_f32 v102, v90, v91
  v_cvt_pk_bf16_f32 v99, v84, v85
  v_cvt_pk_bf16_f32 v103, v92, v93
  v_cvt_pk_bf16_f32 v100, v86, v87
  v_cvt_pk_bf16_f32 v104, v94, v95
  v_cvt_pk_bf16_f32 v101, v88, v89
  v_cvt_pk_bf16_f32 v105, v96, v97
  ds_write_b128 v24, v[98:101] offset:0
  ds_write_b128 v24, v[102:105] offset:1024
  s_waitcnt lgkmcnt(4)
  s_barrier
  s_waitcnt vmcnt(8) lgkmcnt(2)
  ds_read_b64 v[74:75], v22
  ds_read_b64 v[76:77], v23
  v_add_u32 v22, 512, v22
  v_add_u32 v23, 512, v23
  buffer_load_dwordx4 v[26:29], v20, s[12:15], s52 offen
  v_lshlrev_b32 v82, 16, v34
  v_and_b32 v83, 0xffff0000, v34
  v_lshlrev_b32 v90, 16, v38
  v_and_b32 v91, 0xffff0000, v38
  v_lshlrev_b32 v84, 16, v35
  v_and_b32 v85, 0xffff0000, v35
  v_lshlrev_b32 v92, 16, v39
  v_and_b32 v93, 0xffff0000, v39
  v_lshlrev_b32 v86, 16, v36
  v_and_b32 v87, 0xffff0000, v36
  v_lshlrev_b32 v94, 16, v40
  v_and_b32 v95, 0xffff0000, v40
  v_lshlrev_b32 v88, 16, v37
  v_and_b32 v89, 0xffff0000, v37
  v_lshlrev_b32 v96, 16, v41
  v_and_b32 v97, 0xffff0000, v41
  v_fma_f32 v82, v82, v78, v79
  v_fma_f32 v83, v83, v78, v79
  v_fma_f32 v90, v90, v80, v81
  v_fma_f32 v91, v91, v80, v81
  v_fma_f32 v84, v84, v78, v79
  buffer_load_dwordx4 v[30:33], v21, s[12:15], s52 offen
  s_add_u32 s52, s52, 229376
  v_fma_f32 v85, v85, v78, v79
  v_fma_f32 v92, v92, v80, v81
  v_fma_f32 v93, v93, v80, v81
  v_fma_f32 v86, v86, v78, v79
  v_fma_f32 v87, v87, v78, v79
  v_fma_f32 v94, v94, v80, v81
  v_fma_f32 v95, v95, v80, v81
  v_fma_f32 v88, v88, v78, v79
  v_fma_f32 v89, v89, v78, v79
  v_fma_f32 v96, v96, v80, v81
  v_fma_f32 v97, v97, v80, v81
  v_cvt_pk_bf16_f32 v106, v82, v83
  v_cvt_pk_bf16_f32 v110, v90, v91
  v_cvt_pk_bf16_f32 v107, v84, v85
  v_cvt_pk_bf16_f32 v111, v92, v93
  v_cvt_pk_bf16_f32 v108, v86, v87
  v_cvt_pk_bf16_f32 v112, v94, v95
  v_cvt_pk_bf16_f32 v109, v88, v89
  v_cvt_pk_bf16_f32 v113, v96, v97
  ds_write_b128 v24, v[106:109] offset:8192
  ds_write_b128 v24, v[110:113] offset:9216
  s_waitcnt lgkmcnt(4)
  s_barrier
  s_waitcnt vmcnt(8) lgkmcnt(2)
  ds_read_b64 v[78:79], v22
  ds_read_b64 v[80:81], v23
  v_add_u32 v22, 512, v22
  v_add_u32 v23, 512, v23
  buffer_load_dwordx4 v[34:37], v20, s[12:15], s52 offen
  v_lshlrev_b32 v82, 16, v42
  v_and_b32 v83, 0xffff0000, v42
  v_lshlrev_b32 v90, 16, v46
  v_and_b32 v91, 0xffff0000, v46
  v_lshlrev_b32 v84, 16, v43
  v_and_b32 v85, 0xffff0000, v43
  v_lshlrev_b32 v92, 16, v47
  v_and_b32 v93, 0xffff0000, v47
  v_lshlrev_b32 v86, 16, v44
  v_and_b32 v87, 0xffff0000, v44
  v_lshlrev_b32 v94, 16, v48
  v_and_b32 v95, 0xffff0000, v48
  v_lshlrev_b32 v88, 16, v45
  v_and_b32 v89, 0xffff0000, v45
  v_lshlrev_b32 v96, 16, v49
  v_and_b32 v97, 0xffff0000, v49
  v_fma_f32 v82, v82, v74, v75
  v_fma_f32 v83, v83, v74, v75
  v_fma_f32 v90, v90, v76, v77
  v_fma_f32 v91, v91, v76, v77
  v_fma_f32 v84, v84, v74, v75
  buffer_load_dwordx4 v[38:41], v21, s[12:15], s52 offen
  s_add_u32 s52, s52, 229376
  v_fma_f32 v85, v85, v74, v75
  v_fma_f32 v92, v92, v76, v77
  v_fma_f32 v93, v93, v76, v77
  v_fma_f32 v86, v86, v74, v75
  v_fma_f32 v87, v87, v74, v75
  v_fma_f32 v94, v94, v76, v77
  v_fma_f32 v95, v95, v76, v77
  v_fma_f32 v88, v88, v74, v75
  v_fma_f32 v89, v89, v74, v75
  v_fma_f32 v96, v96, v76, v77
  v_fma_f32 v97, v97, v76, v77
  v_cvt_pk_bf16_f32 v98, v82, v83
  v_cvt_pk_bf16_f32 v102, v90, v91
  v_cvt_pk_bf16_f32 v99, v84, v85
  v_cvt_pk_bf16_f32 v103, v92, v93
  v_cvt_pk_bf16_f32 v100, v86, v87
  v_cvt_pk_bf16_f32 v104, v94, v95
  v_cvt_pk_bf16_f32 v101, v88, v89
  v_cvt_pk_bf16_f32 v105, v96, v97
  ds_write_b128 v24, v[98:101] offset:16384
  ds_write_b128 v24, v[102:105] offset:17408
  s_waitcnt lgkmcnt(4)
  s_barrier
  s_waitcnt vmcnt(8) lgkmcnt(2)
  ds_read_b64 v[74:75], v22
  ds_read_b64 v[76:77], v23
  v_add_u32 v22, 512, v22
  v_add_u32 v23, 512, v23
  v_lshlrev_b32 v82, 16, v50
  v_and_b32 v83, 0xffff0000, v50
  v_lshlrev_b32 v90, 16, v54
  v_and_b32 v91, 0xffff0000, v54
  v_lshlrev_b32 v84, 16, v51
  v_and_b32 v85, 0xffff0000, v51
  v_lshlrev_b32 v92, 16, v55
  v_and_b32 v93, 0xffff0000, v55
  v_lshlrev_b32 v86, 16, v52
  v_and_b32 v87, 0xffff0000, v52
  v_lshlrev_b32 v94, 16, v56
  v_and_b32 v95, 0xffff0000, v56
  v_lshlrev_b32 v88, 16, v53
  v_and_b32 v89, 0xffff0000, v53
  v_lshlrev_b32 v96, 16, v57
  v_and_b32 v97, 0xffff0000, v57
  v_fma_f32 v82, v82, v78, v79
  v_fma_f32 v83, v83, v78, v79
  v_fma_f32 v90, v90, v80, v81
  v_fma_f32 v91, v91, v80, v81
  v_fma_f32 v84, v84, v78, v79
  v_fma_f32 v85, v85, v78, v79
  v_fma_f32 v92, v92, v80, v81
  v_fma_f32 v93, v93, v80, v81
  v_fma_f32 v86, v86, v78, v79
  v_fma_f32 v87, v87, v78, v79
  v_fma_f32 v94, v94, v80, v81
  v_fma_f32 v95, v95, v80, v81
  v_fma_f32 v88, v88, v78, v79
  v_fma_f32 v89, v89, v78, v79
  v_fma_f32 v96, v96, v80, v81
  v_fma_f32 v97, v97, v80, v81
  v_cvt_pk_bf16_f32 v106, v82, v83
  v_cvt_pk_bf16_f32 v110, v90, v91
  v_cvt_pk_bf16_f32 v107, v84, v85
  v_cvt_pk_bf16_f32 v111, v92, v93
  v_cvt_pk_bf16_f32 v108, v86, v87
  v_cvt_pk_bf16_f32 v112, v94, v95
  v_cvt_pk_bf16_f32 v109, v88, v89
  v_cvt_pk_bf16_f32 v113, v96, v97
  ds_write_b128 v24, v[106:109] offset:24576
  ds_write_b128 v24, v[110:113] offset:25600
  s_waitcnt lgkmcnt(4)
  s_barrier
  s_waitcnt vmcnt(6) lgkmcnt(2)
  ds_read_b64 v[78:79], v22
  ds_read_b64 v[80:81], v23
  v_add_u32 v22, 512, v22
  v_add_u32 v23, 512, v23
  v_lshlrev_b32 v82, 16, v58
  v_and_b32 v83, 0xffff0000, v58
  v_lshlrev_b32 v90, 16, v62
  v_and_b32 v91, 0xffff0000, v62
  v_lshlrev_b32 v84, 16, v59
  v_and_b32 v85, 0xffff0000, v59
  v_lshlrev_b32 v92, 16, v63
  v_and_b32 v93, 0xffff0000, v63
  v_lshlrev_b32 v86, 16, v60
  v_and_b32 v87, 0xffff0000, v60
  v_lshlrev_b32 v94, 16, v64
  v_and_b32 v95, 0xffff0000, v64
  v_lshlrev_b32 v88, 16, v61
  v_and_b32 v89, 0xffff0000, v61
  v_lshlrev_b32 v96, 16, v65
  v_and_b32 v97, 0xffff0000, v65
  v_fma_f32 v82, v82, v74, v75
  v_fma_f32 v83, v83, v74, v75
  v_fma_f32 v90, v90, v76, v77
  v_fma_f32 v91, v91, v76, v77
  v_fma_f32 v84, v84, v74, v75
  v_fma_f32 v85, v85, v74, v75
  v_fma_f32 v92, v92, v76, v77
  v_fma_f32 v93, v93, v76, v77
  v_fma_f32 v86, v86, v74, v75
  v_fma_f32 v87, v87, v74, v75
  v_fma_f32 v94, v94, v76, v77
  v_fma_f32 v95, v95, v76, v77
  v_fma_f32 v88, v88, v74, v75
  v_fma_f32 v89, v89, v74, v75
  v_fma_f32 v96, v96, v76, v77
  v_fma_f32 v97, v97, v76, v77
  v_cvt_pk_bf16_f32 v98, v82, v83
  v_cvt_pk_bf16_f32 v102, v90, v91
  v_cvt_pk_bf16_f32 v99, v84, v85
  v_cvt_pk_bf16_f32 v103, v92, v93
  v_cvt_pk_bf16_f32 v100, v86, v87
  v_cvt_pk_bf16_f32 v104, v94, v95
  v_cvt_pk_bf16_f32 v101, v88, v89
  v_cvt_pk_bf16_f32 v105, v96, v97
  ds_write_b128 v24, v[98:101] offset:0
  ds_write_b128 v24, v[102:105] offset:1024
  s_waitcnt lgkmcnt(4)
  s_barrier
  s_waitcnt vmcnt(4) lgkmcnt(2)
  ds_read_b64 v[74:75], v22
  ds_read_b64 v[76:77], v23
  v_add_u32 v22, 512, v22
  v_add_u32 v23, 512, v23
  v_lshlrev_b32 v82, 16, v66
  v_and_b32 v83, 0xffff0000, v66
  v_lshlrev_b32 v90, 16, v70
  v_and_b32 v91, 0xffff0000, v70
  v_lshlrev_b32 v84, 16, v67
  v_and_b32 v85, 0xffff0000, v67
  v_lshlrev_b32 v92, 16, v71
  v_and_b32 v93, 0xffff0000, v71
  v_lshlrev_b32 v86, 16, v68
  v_and_b32 v87, 0xffff0000, v68
  v_lshlrev_b32 v94, 16, v72
  v_and_b32 v95, 0xffff0000, v72
  v_lshlrev_b32 v88, 16, v69
  v_and_b32 v89, 0xffff0000, v69
  v_lshlrev_b32 v96, 16, v73
  v_and_b32 v97, 0xffff0000, v73
  v_fma_f32 v82, v82, v78, v79
  v_fma_f32 v83, v83, v78, v79
  v_fma_f32 v90, v90, v80, v81
  v_fma_f32 v91, v91, v80, v81
  v_fma_f32 v84, v84, v78, v79
  v_fma_f32 v85, v85, v78, v79
  v_fma_f32 v92, v92, v80, v81
  v_fma_f32 v93, v93, v80, v81
  v_fma_f32 v86, v86, v78, v79
  v_fma_f32 v87, v87, v78, v79
  v_fma_f32 v94, v94, v80, v81
  v_fma_f32 v95, v95, v80, v81
  v_fma_f32 v88, v88, v78, v79
  v_fma_f32 v89, v89, v78, v79
  v_fma_f32 v96, v96, v80, v81
  v_fma_f32 v97, v97, v80, v81
  v_cvt_pk_bf16_f32 v106, v82, v83
  v_cvt_pk_bf16_f32 v110, v90, v91
  v_cvt_pk_bf16_f32 v107, v84, v85
  v_cvt_pk_bf16_f32 v111, v92, v93
  v_cvt_pk_bf16_f32 v108, v86, v87
  v_cvt_pk_bf16_f32 v112, v94, v95
  v_cvt_pk_bf16_f32 v109, v88, v89
  v_cvt_pk_bf16_f32 v113, v96, v97
  ds_write_b128 v24, v[106:109] offset:8192
  ds_write_b128 v24, v[110:113] offset:9216
  s_waitcnt lgkmcnt(4)
  s_barrier
  s_waitcnt vmcnt(2) lgkmcnt(2)
  ds_read_b64 v[78:79], v22
  ds_read_b64 v[80:81], v23
  v_add_u32 v22, 512, v22
  v_add_u32 v23, 512, v23
  v_lshlrev_b32 v82, 16, v26
  v_and_b32 v83, 0xffff0000, v26
  v_lshlrev_b32 v90, 16, v30
  v_and_b32 v91, 0xffff0000, v30
  v_lshlrev_b32 v84, 16, v27
  v_and_b32 v85, 0xffff0000, v27
  v_lshlrev_b32 v92, 16, v31
  v_and_b32 v93, 0xffff0000, v31
  v_lshlrev_b32 v86, 16, v28
  v_and_b32 v87, 0xffff0000, v28
  v_lshlrev_b32 v94, 16, v32
  v_and_b32 v95, 0xffff0000, v32
  v_lshlrev_b32 v88, 16, v29
  v_and_b32 v89, 0xffff0000, v29
  v_lshlrev_b32 v96, 16, v33
  v_and_b32 v97, 0xffff0000, v33
  v_fma_f32 v82, v82, v74, v75
  v_fma_f32 v83, v83, v74, v75
  v_fma_f32 v90, v90, v76, v77
  v_fma_f32 v91, v91, v76, v77
  v_fma_f32 v84, v84, v74, v75
  v_fma_f32 v85, v85, v74, v75
  v_fma_f32 v92, v92, v76, v77
  v_fma_f32 v93, v93, v76, v77
  v_fma_f32 v86, v86, v74, v75
  v_fma_f32 v87, v87, v74, v75
  v_fma_f32 v94, v94, v76, v77
  v_fma_f32 v95, v95, v76, v77
  v_fma_f32 v88, v88, v74, v75
  v_fma_f32 v89, v89, v74, v75
  v_fma_f32 v96, v96, v76, v77
  v_fma_f32 v97, v97, v76, v77
  v_cvt_pk_bf16_f32 v98, v82, v83
  v_cvt_pk_bf16_f32 v102, v90, v91
  v_cvt_pk_bf16_f32 v99, v84, v85
  v_cvt_pk_bf16_f32 v103, v92, v93
  v_cvt_pk_bf16_f32 v100, v86, v87
  v_cvt_pk_bf16_f32 v104, v94, v95
  v_cvt_pk_bf16_f32 v101, v88, v89
  v_cvt_pk_bf16_f32 v105, v96, v97
  ds_write_b128 v24, v[98:101] offset:16384
  ds_write_b128 v24, v[102:105] offset:17408
  s_waitcnt lgkmcnt(4)
  s_barrier
  s_waitcnt vmcnt(0) lgkmcnt(2)
  v_lshlrev_b32 v82, 16, v34
  v_and_b32 v83, 0xffff0000, v34
  v_lshlrev_b32 v90, 16, v38
  v_and_b32 v91, 0xffff0000, v38
  v_lshlrev_b32 v84, 16, v35
  v_and_b32 v85, 0xffff0000, v35
  v_lshlrev_b32 v92, 16, v39
  v_and_b32 v93, 0xffff0000, v39
  v_lshlrev_b32 v86, 16, v36
  v_and_b32 v87, 0xffff0000, v36
  v_lshlrev_b32 v94, 16, v40
  v_and_b32 v95, 0xffff0000, v40
  v_lshlrev_b32 v88, 16, v37
  v_and_b32 v89, 0xffff0000, v37
  v_lshlrev_b32 v96, 16, v41
  v_and_b32 v97, 0xffff0000, v41
  v_fma_f32 v82, v82, v78, v79
  v_fma_f32 v83, v83, v78, v79
  v_fma_f32 v90, v90, v80, v81
  v_fma_f32 v91, v91, v80, v81
  v_fma_f32 v84, v84, v78, v79
  v_fma_f32 v85, v85, v78, v79
  v_fma_f32 v92, v92, v80, v81
  v_fma_f32 v93, v93, v80, v81
  v_fma_f32 v86, v86, v78, v79
  v_fma_f32 v87, v87, v78, v79
  v_fma_f32 v94, v94, v80, v81
  v_fma_f32 v95, v95, v80, v81
  v_fma_f32 v88, v88, v78, v79
  v_fma_f32 v89, v89, v78, v79
  v_fma_f32 v96, v96, v80, v81
  v_fma_f32 v97, v97, v80, v81
  v_cvt_pk_bf16_f32 v106, v82, v83
  v_cvt_pk_bf16_f32 v110, v90, v91
  v_cvt_pk_bf16_f32 v107, v84, v85
  v_cvt_pk_bf16_f32 v111, v92, v93
  v_cvt_pk_bf16_f32 v108, v86, v87
  v_cvt_pk_bf16_f32 v112, v94, v95
  v_cvt_pk_bf16_f32 v109, v88, v89
  v_cvt_pk_bf16_f32 v113, v96, v97
  ds_write_b128 v24, v[106:109] offset:24576
  ds_write_b128 v24, v[110:113] offset:25600
  s_waitcnt lgkmcnt(2)
  s_barrier
  s_waitcnt lgkmcnt(0)
  s_barrier
  s_barrier
  s_barrier
  s_branch gemm2_kernel_epi
gemm2_kernel_cons:
  v_lshrrev_b32 v20, 0, v2
  v_and_b32 v21, 0, v2
  s_waitcnt lgkmcnt(0)
  s_add_u32 s16, s46, 0x900000
  s_addc_u32 s17, s47, 0
  s_and_b32 s17, s17, 0xffff
  s_mov_b32 s18, 0x380000
  s_mov_b32 s19, 0x20000
  s_mov_b32 s20, s46
  s_mov_b32 s21, s47
  s_and_b32 s21, s21, 0xffff
  s_mov_b32 s22, 0x700000
  s_mov_b32 s23, 0x20000
  s_add_u32 s24, s46, 0x800000
  s_addc_u32 s25, s47, 0
  s_and_b32 s25, s25, 0xffff
  s_mov_b32 s26, 0x1c000
  s_mov_b32 s27, 0x20000
  v_lshlrev_b32 v104, 4, v0
  s_mov_b32 s56, 0
  buffer_load_dwordx4 v[24:27], v104, s[24:27], s56 offen
  s_mov_b32 s56, 16384
  buffer_load_dwordx4 v[28:31], v104, s[24:27], s56 offen
  s_mov_b32 s56, 32768
  buffer_load_dwordx4 v[32:35], v104, s[24:27], s56 offen
  s_mov_b32 s56, 49152
  buffer_load_dwordx4 v[36:39], v104, s[24:27], s56 offen
  s_mov_b32 s56, 65536
  buffer_load_dwordx4 v[40:43], v104, s[24:27], s56 offen
  s_mov_b32 s56, 81920
  buffer_load_dwordx4 v[44:47], v104, s[24:27], s56 offen
  s_mov_b32 s56, 98304
  buffer_load_dwordx4 v[48:51], v104, s[24:27], s56 offen
  s_mov_b32 s56, 8192
  buffer_load_dwordx4 v[52:55], v104, s[24:27], s56 offen
  s_mov_b32 s56, 24576
  buffer_load_dwordx4 v[56:59], v104, s[24:27], s56 offen
  s_mov_b32 s56, 40960
  buffer_load_dwordx4 v[60:63], v104, s[24:27], s56 offen
  s_mov_b32 s56, 57344
  buffer_load_dwordx4 v[64:67], v104, s[24:27], s56 offen
  s_mov_b32 s56, 73728
  buffer_load_dwordx4 v[68:71], v104, s[24:27], s56 offen
  s_mov_b32 s56, 90112
  buffer_load_dwordx4 v[72:75], v104, s[24:27], s56 offen
  s_mov_b32 s56, 106496
  buffer_load_dwordx4 v[76:79], v104, s[24:27], s56 offen
  v_lshrrev_b32 v7, 3, v0
  v_and_b32 v3, 7, v0
  v_mul_u32_u24 v4, 272, v7
  v_lshl_add_u32 v8, v3, 5, v4
  s_mul_i32 s56, s48, 128
  v_add_u32 v4, s56, v7
  s_mov_b32 s57, 1792
  v_mul_lo_u32 v5, v4, s57
  s_mul_i32 s56, s49, 128
  v_lshl_add_u32 v6, v3, 4, v5
  v_add_u32 v9, s56, v6
  s_mov_b32 s57, 3584
  v_mul_lo_u32 v5, v4, s57
  v_lshl_add_u32 v5, v3, 4, v5
  s_mul_i32 s56, s49, 128
  v_add_u32 v5, s56, v5
  s_mov_b32 s56, 0
  buffer_load_dwordx4 v[10:13], v5, s[20:23], s56 offen
  s_mov_b32 s56, 229376
  buffer_load_dwordx4 v[14:17], v5, s[20:23], s56 offen
  s_mov_b32 s28, s38
  s_mov_b32 s29, s39
  s_and_b32 s29, s29, 0xffff
  s_mov_b32 s30, 0x1000
  s_mov_b32 s31, 0x20000
  v_lshlrev_b32 v6, 1, v4
  buffer_load_ushort v18, v6, s[28:31], 0 offen offset:0
  buffer_load_ushort v19, v6, s[28:31], 0 offen offset:128
  v_and_b32 v3, 31, v1
  v_mul_u32_u24 v4, 32, v20
  v_add_u32 v3, v3, v4
  v_mul_u32_u24 v106, 272, v3
  v_mul_u32_u24 v5, 256, v21
  v_add_u32 v106, v106, v5
  v_lshrrev_b32 v5, 5, v1
  v_lshl_add_u32 v106, v5, 4, v106
  v_bfe_u32 v4, v3, 1, 3
  v_lshrrev_b32 v5, 5, v1
  v_xor_b32 v5, v5, v4
  v_lshlrev_b32 v5, 4, v5
  v_lshlrev_b32 v3, 7, v3
  v_add_u32 v105, v3, v5
  v_lshrrev_b32 v3, 5, v1
  v_lshlrev_b32 v3, 3, v3
  v_bfe_u32 v4, v1, 2, 2
  v_add_u32 v3, v3, v4
  v_lshrrev_b32 v4, 1, v4
  v_lshlrev_b32 v4, 2, v4
  v_mul_u32_u24 v5, 8, v21
  v_bfe_u32 v6, v1, 4, 1
  v_lshl_add_u32 v5, v6, 1, v5
  v_bfe_u32 v6, v1, 1, 1
  v_add_u32 v5, v5, v6
  v_xor_b32 v5, v5, v4
  v_lshlrev_b32 v5, 4, v5
  v_lshlrev_b32 v3, 7, v3
  v_add_u32 v3, v3, v5
  v_and_b32 v6, 1, v1
  v_lshl_add_u32 v107, v6, 3, v3
  v_add_u32 v107, 114688, v107
  v_xor_b32 v108, 0, v105
  v_xor_b32 v109, 32, v105
  v_xor_b32 v110, 64, v105
  v_xor_b32 v111, 96, v105
  v_xor_b32 v112, 0, v105
  v_add_u32 v112, 16384, v112
  v_xor_b32 v113, 32, v105
  v_add_u32 v113, 16384, v113
  v_xor_b32 v114, 64, v105
  v_add_u32 v114, 16384, v114
  v_xor_b32 v115, 96, v105
  v_add_u32 v115, 16384, v115
  v_xor_b32 v116, 0, v105
  v_add_u32 v116, 32768, v116
  v_xor_b32 v117, 32, v105
  v_add_u32 v117, 32768, v117
  v_xor_b32 v118, 64, v105
  v_add_u32 v118, 32768, v118
  v_xor_b32 v119, 96, v105
  v_add_u32 v119, 32768, v119
  v_xor_b32 v120, 0, v105
  v_add_u32 v120, 49152, v120
  v_xor_b32 v121, 32, v105
  v_add_u32 v121, 49152, v121
  v_xor_b32 v122, 64, v105
  v_add_u32 v122, 49152, v122
  v_xor_b32 v123, 96, v105
  v_add_u32 v123, 49152, v123
  v_xor_b32 v124, 0, v105
  v_add_u32 v124, 65536, v124
  v_xor_b32 v125, 32, v105
  v_add_u32 v125, 65536, v125
  v_xor_b32 v126, 64, v105
  v_add_u32 v126, 65536, v126
  v_xor_b32 v127, 96, v105
  v_add_u32 v127, 65536, v127
  v_xor_b32 v128, 0, v105
  v_add_u32 v128, 81920, v128
  v_xor_b32 v129, 32, v105
  v_add_u32 v129, 81920, v129
  v_xor_b32 v130, 64, v105
  v_add_u32 v130, 81920, v130
  v_xor_b32 v131, 96, v105
  v_add_u32 v131, 81920, v131
  v_xor_b32 v132, 0, v105
  v_add_u32 v132, 98304, v132
  v_xor_b32 v133, 32, v105
  v_add_u32 v133, 98304, v133
  v_xor_b32 v134, 64, v105
  v_add_u32 v134, 98304, v134
  v_xor_b32 v135, 96, v105
  v_add_u32 v135, 98304, v135
  v_xor_b32 v136, 0, v107
  v_xor_b32 v137, 64, v107
  v_xor_b32 v138, 0, v107
  v_add_u32 v138, 8192, v138
  v_xor_b32 v139, 64, v107
  v_add_u32 v139, 8192, v139
  v_xor_b32 v140, 0, v107
  v_add_u32 v140, 16384, v140
  v_xor_b32 v141, 64, v107
  v_add_u32 v141, 16384, v141
  v_xor_b32 v142, 0, v107
  v_add_u32 v142, 24576, v142
  v_xor_b32 v143, 64, v107
  v_add_u32 v143, 24576, v143
  v_mov_b32 v160, 0x43000000
  v_add_u32 v104, 147456, v104
  s_waitcnt vmcnt(4)
  v_add_f32 v144, v24, v28
  v_add_f32 v148, v25, v29
  v_add_f32 v145, v26, v30
  v_add_f32 v149, v27, v31
  v_add_f32 v146, v52, v56
  v_add_f32 v150, v53, v57
  v_add_f32 v147, v54, v58
  v_add_f32 v151, v55, v59
  v_add_f32 v144, v144, v32
  v_add_f32 v148, v148, v33
  v_add_f32 v145, v145, v34
  v_add_f32 v149, v149, v35
  v_add_f32 v146, v146, v60
  v_add_f32 v150, v150, v61
  v_add_f32 v147, v147, v62
  v_add_f32 v151, v151, v63
  v_add_f32 v144, v144, v36
  v_add_f32 v148, v148, v37
  v_add_f32 v145, v145, v38
  v_add_f32 v149, v149, v39
  v_add_f32 v146, v146, v64
  v_add_f32 v150, v150, v65
  v_add_f32 v147, v147, v66
  v_add_f32 v151, v151, v67
  v_add_f32 v144, v144, v40
  v_add_f32 v148, v148, v41
  v_add_f32 v145, v145, v42
  v_add_f32 v149, v149, v43
  v_add_f32 v146, v146, v68
  v_add_f32 v150, v150, v69
  v_add_f32 v147, v147, v70
  v_add_f32 v151, v151, v71
  v_add_f32 v144, v144, v44
  v_add_f32 v148, v148, v45
  v_add_f32 v145, v145, v46
  v_add_f32 v149, v149, v47
  v_add_f32 v146, v146, v72
  v_add_f32 v150, v150, v73
  v_add_f32 v147, v147, v74
  v_add_f32 v151, v151, v75
  v_add_f32 v144, v144, v48
  v_add_f32 v148, v148, v49
  v_add_f32 v145, v145, v50
  v_add_f32 v149, v149, v51
  v_add_f32 v146, v146, v76
  v_add_f32 v150, v150, v77
  v_add_f32 v147, v147, v78
  v_add_f32 v151, v151, v79
  v_mul_f32 v144, 0x3e124925, v144
  v_mov_b32 v156, 0
  v_mul_f32 v145, 0x3e124925, v145
  v_mov_b32 v157, 0
  v_mul_f32 v146, 0x3e124925, v146
  v_mov_b32 v158, 0
  v_mul_f32 v147, 0x3e124925, v147
  v_mov_b32 v159, 0
  v_sub_f32 v152, v24, v144
  v_sub_f32 v153, v26, v145
  v_sub_f32 v154, v52, v146
  v_sub_f32 v155, v54, v147
  v_fmac_f32 v156, v152, v152
  v_fmac_f32 v157, v153, v153
  v_fmac_f32 v158, v154, v154
  v_fmac_f32 v159, v155, v155
  v_sub_f32 v152, v28, v144
  v_sub_f32 v153, v30, v145
  v_sub_f32 v154, v56, v146
  v_sub_f32 v155, v58, v147
  v_fmac_f32 v156, v152, v152
  v_fmac_f32 v157, v153, v153
  v_fmac_f32 v158, v154, v154
  v_fmac_f32 v159, v155, v155
  v_sub_f32 v152, v32, v144
  v_sub_f32 v153, v34, v145
  v_sub_f32 v154, v60, v146
  v_sub_f32 v155, v62, v147
  v_fmac_f32 v156, v152, v152
  v_fmac_f32 v157, v153, v153
  v_fmac_f32 v158, v154, v154
  v_fmac_f32 v159, v155, v155
  v_sub_f32 v152, v36, v144
  v_sub_f32 v153, v38, v145
  v_sub_f32 v154, v64, v146
  v_sub_f32 v155, v66, v147
  v_fmac_f32 v156, v152, v152
  v_fmac_f32 v157, v153, v153
  v_fmac_f32 v158, v154, v154
  v_fmac_f32 v159, v155, v155
  v_sub_f32 v152, v40, v144
  v_sub_f32 v153, v42, v145
  v_sub_f32 v154, v68, v146
  v_sub_f32 v155, v70, v147
  v_fmac_f32 v156, v152, v152
  v_fmac_f32 v157, v153, v153
  v_fmac_f32 v158, v154, v154
  v_fmac_f32 v159, v155, v155
  v_sub_f32 v152, v44, v144
  v_sub_f32 v153, v46, v145
  v_sub_f32 v154, v72, v146
  v_sub_f32 v155, v74, v147
  v_fmac_f32 v156, v152, v152
  v_fmac_f32 v157, v153, v153
  v_fmac_f32 v158, v154, v154
  v_fmac_f32 v159, v155, v155
  v_sub_f32 v152, v48, v144
  v_sub_f32 v153, v50, v145
  v_sub_f32 v154, v76, v146
  v_sub_f32 v155, v78, v147
  v_fmac_f32 v156, v152, v152
  v_fmac_f32 v157, v153, v153
  v_fmac_f32 v158, v154, v154
  v_fmac_f32 v159, v155, v155
  v_fmac_f32 v148, v156, v160
  v_fmac_f32 v149, v157, v160
  v_fmac_f32 v150, v158, v160
  v_fmac_f32 v151, v159, v160
  v_mul_f32 v148, 0x3a924925, v148
  v_mul_f32 v149, 0x3a924925, v149
  v_mul_f32 v150, 0x3a924925, v150
  v_mul_f32 v151, 0x3a924925, v151
  v_cvt_pk_bf16_f32 v152, v144, v148
  v_cvt_pk_bf16_f32 v153, v145, v149
  v_cvt_pk_bf16_f32 v154, v146, v150
  v_cvt_pk_bf16_f32 v155, v147, v151
  v_lshlrev_b32 v144, 16, v152
  v_and_b32 v148, 0xffff0000, v152
  v_lshlrev_b32 v145, 16, v153
  v_and_b32 v149, 0xffff0000, v153
  v_lshlrev_b32 v146, 16, v154
  v_and_b32 v150, 0xffff0000, v154
  v_lshlrev_b32 v147, 16, v155
  v_and_b32 v151, 0xffff0000, v155
  v_add_f32 v148, 0x3727c5ac, v148
  v_add_f32 v149, 0x3727c5ac, v149
  v_add_f32 v150, 0x3727c5ac, v150
  v_add_f32 v151, 0x3727c5ac, v151
  v_cvt_pk_bf16_f32 v148, v148, v148
  v_cvt_pk_bf16_f32 v149, v149, v149
  v_cvt_pk_bf16_f32 v150, v150, v150
  v_cvt_pk_bf16_f32 v151, v151, v151
  v_lshlrev_b32 v148, 16, v148
  v_lshlrev_b32 v149, 16, v149
  v_lshlrev_b32 v150, 16, v150
  v_lshlrev_b32 v151, 16, v151
  v_sqrt_f32 v148, v148
  v_sqrt_f32 v149, v149
  v_sqrt_f32 v150, v150
  v_sqrt_f32 v151, v151
  v_cvt_pk_bf16_f32 v148, v148, v148
  v_cvt_pk_bf16_f32 v149, v149, v149
  v_cvt_pk_bf16_f32 v150, v150, v150
  v_cvt_pk_bf16_f32 v151, v151, v151
  v_lshlrev_b32 v148, 16, v148
  v_lshlrev_b32 v149, 16, v149
  v_lshlrev_b32 v150, 16, v150
  v_lshlrev_b32 v151, 16, v151
  v_rcp_f32 v152, v148
  v_rcp_f32 v154, v149
  v_rcp_f32 v156, v150
  v_rcp_f32 v158, v151
  v_mul_f32 v153, v144, v152
  v_mul_f32 v155, v145, v154
  v_mul_f32 v157, v146, v156
  v_mul_f32 v159, v147, v158
  v_sub_f32 v153, 0, v153
  v_sub_f32 v155, 0, v155
  v_sub_f32 v157, 0, v157
  v_sub_f32 v159, 0, v159
  ds_write_b128 v104, v[152:155] offset:0
  ds_write_b128 v104, v[156:159] offset:8192
  s_waitcnt lgkmcnt(0)
  s_barrier
  v_mov_b32 v24, 0
  v_mov_b32 v25, 0
  v_mov_b32 v26, 0
  v_mov_b32 v27, 0
  v_mov_b32 v28, 0
  v_mov_b32 v29, 0
  v_mov_b32 v30, 0
  v_mov_b32 v31, 0
  v_mov_b32 v32, 0
  v_mov_b32 v33, 0
  v_mov_b32 v34, 0
  v_mov_b32 v35, 0
  v_mov_b32 v36, 0
  v_mov_b32 v37, 0
  v_mov_b32 v38, 0
  v_mov_b32 v39, 0
  v_mov_b32 v40, 0
  v_mov_b32 v41, 0
  v_mov_b32 v42, 0
  v_mov_b32 v43, 0
  v_mov_b32 v44, 0
  v_mov_b32 v45, 0
  v_mov_b32 v46, 0
  v_mov_b32 v47, 0
  v_mov_b32 v48, 0
  v_mov_b32 v49, 0
  v_mov_b32 v50, 0
  v_mov_b32 v51, 0
  v_mov_b32 v52, 0
  v_mov_b32 v53, 0
  v_mov_b32 v54, 0
  v_mov_b32 v55, 0
  s_barrier
  ds_read_b64_tr_b16 v[72:73], v136 offset:0
  ds_read_b64_tr_b16 v[74:75], v136 offset:512
  ds_read_b64_tr_b16 v[76:77], v137 offset:0
  ds_read_b64_tr_b16 v[78:79], v137 offset:512
  ds_read_b128 v[56:59], v108 offset:0
  ds_read_b64_tr_b16 v[80:81], v136 offset:2048
  ds_read_b64_tr_b16 v[82:83], v136 offset:2560
  ds_read_b64_tr_b16 v[84:85], v137 offset:2048
  ds_read_b64_tr_b16 v[86:87], v137 offset:2560
  ds_read_b128 v[60:63], v109 offset:0
  ds_read_b64_tr_b16 v[88:89], v136 offset:4096
  ds_read_b64_tr_b16 v[90:91], v136 offset:4608
  ds_read_b64_tr_b16 v[92:93], v137 offset:4096
  ds_read_b64_tr_b16 v[94:95], v137 offset:4608
  ds_read_b128 v[64:67], v110 offset:0
  ds_read_b64_tr_b16 v[96:97], v136 offset:6144
  ds_read_b64_tr_b16 v[98:99], v136 offset:6656
  ds_read_b64_tr_b16 v[100:101], v137 offset:6144
  ds_read_b64_tr_b16 v[102:103], v137 offset:6656
  ds_read_b128 v[68:71], v111 offset:0
  s_waitcnt lgkmcnt(15)
  v_mfma_f32_32x32x16_bf16 v[24:39], v[72:75], v[56:59], v[24:39]
  v_mfma_f32_32x32x16_bf16 v[40:55], v[76:79], v[56:59], v[40:55]
  ds_read_b64_tr_b16 v[72:73], v138 offset:0
  ds_read_b64_tr_b16 v[74:75], v138 offset:512
  ds_read_b64_tr_b16 v[76:77], v139 offset:0
  ds_read_b64_tr_b16 v[78:79], v139 offset:512
  ds_read_b128 v[56:59], v112 offset:0
  s_waitcnt lgkmcnt(15)
  v_mfma_f32_32x32x16_bf16 v[24:39], v[80:83], v[60:63], v[24:39]
  v_mfma_f32_32x32x16_bf16 v[40:55], v[84:87], v[60:63], v[40:55]
  ds_read_b64_tr_b16 v[80:81], v138 offset:2048
  ds_read_b64_tr_b16 v[82:83], v138 offset:2560
  ds_read_b64_tr_b16 v[84:85], v139 offset:2048
  ds_read_b64_tr_b16 v[86:87], v139 offset:2560
  ds_read_b128 v[60:63], v113 offset:0
  s_waitcnt lgkmcnt(15)
  v_mfma_f32_32x32x16_bf16 v[24:39], v[88:91], v[64:67], v[24:39]
  v_mfma_f32_32x32x16_bf16 v[40:55], v[92:95], v[64:67], v[40:55]
  ds_read_b64_tr_b16 v[88:89], v138 offset:4096
  ds_read_b64_tr_b16 v[90:91], v138 offset:4608
  ds_read_b64_tr_b16 v[92:93], v139 offset:4096
  ds_read_b64_tr_b16 v[94:95], v139 offset:4608
  ds_read_b128 v[64:67], v114 offset:0
  s_waitcnt lgkmcnt(15)
  v_mfma_f32_32x32x16_bf16 v[24:39], v[96:99], v[68:71], v[24:39]
  v_mfma_f32_32x32x16_bf16 v[40:55], v[100:103], v[68:71], v[40:55]
  s_barrier
  ds_read_b64_tr_b16 v[96:97], v138 offset:6144
  ds_read_b64_tr_b16 v[98:99], v138 offset:6656
  ds_read_b64_tr_b16 v[100:101], v139 offset:6144
  ds_read_b64_tr_b16 v[102:103], v139 offset:6656
  ds_read_b128 v[68:71], v115 offset:0
  s_waitcnt lgkmcnt(15)
  v_mfma_f32_32x32x16_bf16 v[24:39], v[72:75], v[56:59], v[24:39]
  v_mfma_f32_32x32x16_bf16 v[40:55], v[76:79], v[56:59], v[40:55]
  ds_read_b64_tr_b16 v[72:73], v140 offset:0
  ds_read_b64_tr_b16 v[74:75], v140 offset:512
  ds_read_b64_tr_b16 v[76:77], v141 offset:0
  ds_read_b64_tr_b16 v[78:79], v141 offset:512
  ds_read_b128 v[56:59], v116 offset:0
  s_waitcnt lgkmcnt(15)
  v_mfma_f32_32x32x16_bf16 v[24:39], v[80:83], v[60:63], v[24:39]
  v_mfma_f32_32x32x16_bf16 v[40:55], v[84:87], v[60:63], v[40:55]
  ds_read_b64_tr_b16 v[80:81], v140 offset:2048
  ds_read_b64_tr_b16 v[82:83], v140 offset:2560
  ds_read_b64_tr_b16 v[84:85], v141 offset:2048
  ds_read_b64_tr_b16 v[86:87], v141 offset:2560
  ds_read_b128 v[60:63], v117 offset:0
  s_waitcnt lgkmcnt(15)
  v_mfma_f32_32x32x16_bf16 v[24:39], v[88:91], v[64:67], v[24:39]
  v_mfma_f32_32x32x16_bf16 v[40:55], v[92:95], v[64:67], v[40:55]
  ds_read_b64_tr_b16 v[88:89], v140 offset:4096
  ds_read_b64_tr_b16 v[90:91], v140 offset:4608
  ds_read_b64_tr_b16 v[92:93], v141 offset:4096
  ds_read_b64_tr_b16 v[94:95], v141 offset:4608
  ds_read_b128 v[64:67], v118 offset:0
  s_waitcnt lgkmcnt(15)
  v_mfma_f32_32x32x16_bf16 v[24:39], v[96:99], v[68:71], v[24:39]
  v_mfma_f32_32x32x16_bf16 v[40:55], v[100:103], v[68:71], v[40:55]
  s_barrier
  ds_read_b64_tr_b16 v[96:97], v140 offset:6144
  ds_read_b64_tr_b16 v[98:99], v140 offset:6656
  ds_read_b64_tr_b16 v[100:101], v141 offset:6144
  ds_read_b64_tr_b16 v[102:103], v141 offset:6656
  ds_read_b128 v[68:71], v119 offset:0
  s_waitcnt lgkmcnt(15)
  v_mfma_f32_32x32x16_bf16 v[24:39], v[72:75], v[56:59], v[24:39]
  v_mfma_f32_32x32x16_bf16 v[40:55], v[76:79], v[56:59], v[40:55]
  ds_read_b64_tr_b16 v[72:73], v142 offset:0
  ds_read_b64_tr_b16 v[74:75], v142 offset:512
  ds_read_b64_tr_b16 v[76:77], v143 offset:0
  ds_read_b64_tr_b16 v[78:79], v143 offset:512
  ds_read_b128 v[56:59], v120 offset:0
  s_waitcnt lgkmcnt(15)
  v_mfma_f32_32x32x16_bf16 v[24:39], v[80:83], v[60:63], v[24:39]
  v_mfma_f32_32x32x16_bf16 v[40:55], v[84:87], v[60:63], v[40:55]
  ds_read_b64_tr_b16 v[80:81], v142 offset:2048
  ds_read_b64_tr_b16 v[82:83], v142 offset:2560
  ds_read_b64_tr_b16 v[84:85], v143 offset:2048
  ds_read_b64_tr_b16 v[86:87], v143 offset:2560
  ds_read_b128 v[60:63], v121 offset:0
  s_waitcnt lgkmcnt(15)
  v_mfma_f32_32x32x16_bf16 v[24:39], v[88:91], v[64:67], v[24:39]
  v_mfma_f32_32x32x16_bf16 v[40:55], v[92:95], v[64:67], v[40:55]
  ds_read_b64_tr_b16 v[88:89], v142 offset:4096
  ds_read_b64_tr_b16 v[90:91], v142 offset:4608
  ds_read_b64_tr_b16 v[92:93], v143 offset:4096
  ds_read_b64_tr_b16 v[94:95], v143 offset:4608
  ds_read_b128 v[64:67], v122 offset:0
  s_waitcnt lgkmcnt(15)
  v_mfma_f32_32x32x16_bf16 v[24:39], v[96:99], v[68:71], v[24:39]
  v_mfma_f32_32x32x16_bf16 v[40:55], v[100:103], v[68:71], v[40:55]
  s_barrier
  ds_read_b64_tr_b16 v[96:97], v142 offset:6144
  ds_read_b64_tr_b16 v[98:99], v142 offset:6656
  ds_read_b64_tr_b16 v[100:101], v143 offset:6144
  ds_read_b64_tr_b16 v[102:103], v143 offset:6656
  ds_read_b128 v[68:71], v123 offset:0
  s_waitcnt lgkmcnt(15)
  v_mfma_f32_32x32x16_bf16 v[24:39], v[72:75], v[56:59], v[24:39]
  v_mfma_f32_32x32x16_bf16 v[40:55], v[76:79], v[56:59], v[40:55]
  ds_read_b64_tr_b16 v[72:73], v136 offset:0
  ds_read_b64_tr_b16 v[74:75], v136 offset:512
  ds_read_b64_tr_b16 v[76:77], v137 offset:0
  ds_read_b64_tr_b16 v[78:79], v137 offset:512
  ds_read_b128 v[56:59], v124 offset:0
  s_waitcnt lgkmcnt(15)
  v_mfma_f32_32x32x16_bf16 v[24:39], v[80:83], v[60:63], v[24:39]
  v_mfma_f32_32x32x16_bf16 v[40:55], v[84:87], v[60:63], v[40:55]
  ds_read_b64_tr_b16 v[80:81], v136 offset:2048
  ds_read_b64_tr_b16 v[82:83], v136 offset:2560
  ds_read_b64_tr_b16 v[84:85], v137 offset:2048
  ds_read_b64_tr_b16 v[86:87], v137 offset:2560
  ds_read_b128 v[60:63], v125 offset:0
  s_waitcnt lgkmcnt(15)
  v_mfma_f32_32x32x16_bf16 v[24:39], v[88:91], v[64:67], v[24:39]
  v_mfma_f32_32x32x16_bf16 v[40:55], v[92:95], v[64:67], v[40:55]
  ds_read_b64_tr_b16 v[88:89], v136 offset:4096
  ds_read_b64_tr_b16 v[90:91], v136 offset:4608
  ds_read_b64_tr_b16 v[92:93], v137 offset:4096
  ds_read_b64_tr_b16 v[94:95], v137 offset:4608
  ds_read_b128 v[64:67], v126 offset:0
  s_waitcnt lgkmcnt(15)
  v_mfma_f32_32x32x16_bf16 v[24:39], v[96:99], v[68:71], v[24:39]
  v_mfma_f32_32x32x16_bf16 v[40:55], v[100:103], v[68:71], v[40:55]
  s_barrier
  ds_read_b64_tr_b16 v[96:97], v136 offset:6144
  ds_read_b64_tr_b16 v[98:99], v136 offset:6656
  ds_read_b64_tr_b16 v[100:101], v137 offset:6144
  ds_read_b64_tr_b16 v[102:103], v137 offset:6656
  ds_read_b128 v[68:71], v127 offset:0
  s_waitcnt lgkmcnt(15)
  v_mfma_f32_32x32x16_bf16 v[24:39], v[72:75], v[56:59], v[24:39]
  v_mfma_f32_32x32x16_bf16 v[40:55], v[76:79], v[56:59], v[40:55]
  ds_read_b64_tr_b16 v[72:73], v138 offset:0
  ds_read_b64_tr_b16 v[74:75], v138 offset:512
  ds_read_b64_tr_b16 v[76:77], v139 offset:0
  ds_read_b64_tr_b16 v[78:79], v139 offset:512
  ds_read_b128 v[56:59], v128 offset:0
  s_waitcnt lgkmcnt(15)
  v_mfma_f32_32x32x16_bf16 v[24:39], v[80:83], v[60:63], v[24:39]
  v_mfma_f32_32x32x16_bf16 v[40:55], v[84:87], v[60:63], v[40:55]
  ds_read_b64_tr_b16 v[80:81], v138 offset:2048
  ds_read_b64_tr_b16 v[82:83], v138 offset:2560
  ds_read_b64_tr_b16 v[84:85], v139 offset:2048
  ds_read_b64_tr_b16 v[86:87], v139 offset:2560
  ds_read_b128 v[60:63], v129 offset:0
  s_waitcnt lgkmcnt(15)
  v_mfma_f32_32x32x16_bf16 v[24:39], v[88:91], v[64:67], v[24:39]
  v_mfma_f32_32x32x16_bf16 v[40:55], v[92:95], v[64:67], v[40:55]
  ds_read_b64_tr_b16 v[88:89], v138 offset:4096
  ds_read_b64_tr_b16 v[90:91], v138 offset:4608
  ds_read_b64_tr_b16 v[92:93], v139 offset:4096
  ds_read_b64_tr_b16 v[94:95], v139 offset:4608
  ds_read_b128 v[64:67], v130 offset:0
  s_waitcnt lgkmcnt(15)
  v_mfma_f32_32x32x16_bf16 v[24:39], v[96:99], v[68:71], v[24:39]
  v_mfma_f32_32x32x16_bf16 v[40:55], v[100:103], v[68:71], v[40:55]
  s_barrier
  ds_read_b64_tr_b16 v[96:97], v138 offset:6144
  ds_read_b64_tr_b16 v[98:99], v138 offset:6656
  ds_read_b64_tr_b16 v[100:101], v139 offset:6144
  ds_read_b64_tr_b16 v[102:103], v139 offset:6656
  ds_read_b128 v[68:71], v131 offset:0
  s_waitcnt lgkmcnt(15)
  v_mfma_f32_32x32x16_bf16 v[24:39], v[72:75], v[56:59], v[24:39]
  v_mfma_f32_32x32x16_bf16 v[40:55], v[76:79], v[56:59], v[40:55]
  ds_read_b64_tr_b16 v[72:73], v140 offset:0
  ds_read_b64_tr_b16 v[74:75], v140 offset:512
  ds_read_b64_tr_b16 v[76:77], v141 offset:0
  ds_read_b64_tr_b16 v[78:79], v141 offset:512
  ds_read_b128 v[56:59], v132 offset:0
  s_waitcnt lgkmcnt(15)
  v_mfma_f32_32x32x16_bf16 v[24:39], v[80:83], v[60:63], v[24:39]
  v_mfma_f32_32x32x16_bf16 v[40:55], v[84:87], v[60:63], v[40:55]
  ds_read_b64_tr_b16 v[80:81], v140 offset:2048
  ds_read_b64_tr_b16 v[82:83], v140 offset:2560
  ds_read_b64_tr_b16 v[84:85], v141 offset:2048
  ds_read_b64_tr_b16 v[86:87], v141 offset:2560
  ds_read_b128 v[60:63], v133 offset:0
  s_waitcnt lgkmcnt(15)
  v_mfma_f32_32x32x16_bf16 v[24:39], v[88:91], v[64:67], v[24:39]
  v_mfma_f32_32x32x16_bf16 v[40:55], v[92:95], v[64:67], v[40:55]
  ds_read_b64_tr_b16 v[88:89], v140 offset:4096
  ds_read_b64_tr_b16 v[90:91], v140 offset:4608
  ds_read_b64_tr_b16 v[92:93], v141 offset:4096
  ds_read_b64_tr_b16 v[94:95], v141 offset:4608
  ds_read_b128 v[64:67], v134 offset:0
  s_waitcnt lgkmcnt(15)
  v_mfma_f32_32x32x16_bf16 v[24:39], v[96:99], v[68:71], v[24:39]
  v_mfma_f32_32x32x16_bf16 v[40:55], v[100:103], v[68:71], v[40:55]
  s_barrier
  ds_read_b64_tr_b16 v[96:97], v140 offset:6144
  ds_read_b64_tr_b16 v[98:99], v140 offset:6656
  ds_read_b64_tr_b16 v[100:101], v141 offset:6144
  ds_read_b64_tr_b16 v[102:103], v141 offset:6656
  ds_read_b128 v[68:71], v135 offset:0
  s_waitcnt lgkmcnt(15)
  v_mfma_f32_32x32x16_bf16 v[24:39], v[72:75], v[56:59], v[24:39]
  v_mfma_f32_32x32x16_bf16 v[40:55], v[76:79], v[56:59], v[40:55]
  ds_read_b64_tr_b16 v[72:73], v142 offset:0
  ds_read_b64_tr_b16 v[74:75], v142 offset:512
  ds_read_b64_tr_b16 v[76:77], v143 offset:0
  ds_read_b64_tr_b16 v[78:79], v143 offset:512
  ds_read_b128 v[56:59], v108 offset:0
  s_waitcnt lgkmcnt(15)
  v_mfma_f32_32x32x16_bf16 v[24:39], v[80:83], v[60:63], v[24:39]
  v_mfma_f32_32x32x16_bf16 v[40:55], v[84:87], v[60:63], v[40:55]
  ds_read_b64_tr_b16 v[80:81], v142 offset:2048
  ds_read_b64_tr_b16 v[82:83], v142 offset:2560
  ds_read_b64_tr_b16 v[84:85], v143 offset:2048
  ds_read_b64_tr_b16 v[86:87], v143 offset:2560
  ds_read_b128 v[60:63], v109 offset:0
  s_waitcnt lgkmcnt(15)
  v_mfma_f32_32x32x16_bf16 v[24:39], v[88:91], v[64:67], v[24:39]
  v_mfma_f32_32x32x16_bf16 v[40:55], v[92:95], v[64:67], v[40:55]
  ds_read_b64_tr_b16 v[88:89], v142 offset:4096
  ds_read_b64_tr_b16 v[90:91], v142 offset:4608
  ds_read_b64_tr_b16 v[92:93], v143 offset:4096
  ds_read_b64_tr_b16 v[94:95], v143 offset:4608
  ds_read_b128 v[64:67], v110 offset:0
  s_waitcnt lgkmcnt(15)
  v_mfma_f32_32x32x16_bf16 v[24:39], v[96:99], v[68:71], v[24:39]
  v_mfma_f32_32x32x16_bf16 v[40:55], v[100:103], v[68:71], v[40:55]
  s_barrier
  ds_read_b64_tr_b16 v[96:97], v142 offset:6144
  ds_read_b64_tr_b16 v[98:99], v142 offset:6656
  ds_read_b64_tr_b16 v[100:101], v143 offset:6144
  ds_read_b64_tr_b16 v[102:103], v143 offset:6656
  ds_read_b128 v[68:71], v111 offset:0
  s_waitcnt lgkmcnt(15)
  v_mfma_f32_32x32x16_bf16 v[24:39], v[72:75], v[56:59], v[24:39]
  v_mfma_f32_32x32x16_bf16 v[40:55], v[76:79], v[56:59], v[40:55]
  ds_read_b64_tr_b16 v[72:73], v136 offset:0
  ds_read_b64_tr_b16 v[74:75], v136 offset:512
  ds_read_b64_tr_b16 v[76:77], v137 offset:0
  ds_read_b64_tr_b16 v[78:79], v137 offset:512
  ds_read_b128 v[56:59], v112 offset:0
  s_waitcnt lgkmcnt(15)
  v_mfma_f32_32x32x16_bf16 v[24:39], v[80:83], v[60:63], v[24:39]
  v_mfma_f32_32x32x16_bf16 v[40:55], v[84:87], v[60:63], v[40:55]
  ds_read_b64_tr_b16 v[80:81], v136 offset:2048
  ds_read_b64_tr_b16 v[82:83], v136 offset:2560
  ds_read_b64_tr_b16 v[84:85], v137 offset:2048
  ds_read_b64_tr_b16 v[86:87], v137 offset:2560
  ds_read_b128 v[60:63], v113 offset:0
  s_waitcnt lgkmcnt(15)
  v_mfma_f32_32x32x16_bf16 v[24:39], v[88:91], v[64:67], v[24:39]
  v_mfma_f32_32x32x16_bf16 v[40:55], v[92:95], v[64:67], v[40:55]
  ds_read_b64_tr_b16 v[88:89], v136 offset:4096
  ds_read_b64_tr_b16 v[90:91], v136 offset:4608
  ds_read_b64_tr_b16 v[92:93], v137 offset:4096
  ds_read_b64_tr_b16 v[94:95], v137 offset:4608
  ds_read_b128 v[64:67], v114 offset:0
  s_waitcnt lgkmcnt(15)
  v_mfma_f32_32x32x16_bf16 v[24:39], v[96:99], v[68:71], v[24:39]
  v_mfma_f32_32x32x16_bf16 v[40:55], v[100:103], v[68:71], v[40:55]
  s_barrier
  ds_read_b64_tr_b16 v[96:97], v136 offset:6144
  ds_read_b64_tr_b16 v[98:99], v136 offset:6656
  ds_read_b64_tr_b16 v[100:101], v137 offset:6144
  ds_read_b64_tr_b16 v[102:103], v137 offset:6656
  ds_read_b128 v[68:71], v115 offset:0
  s_waitcnt lgkmcnt(15)
  v_mfma_f32_32x32x16_bf16 v[24:39], v[72:75], v[56:59], v[24:39]
  v_mfma_f32_32x32x16_bf16 v[40:55], v[76:79], v[56:59], v[40:55]
  ds_read_b64_tr_b16 v[72:73], v138 offset:0
  ds_read_b64_tr_b16 v[74:75], v138 offset:512
  ds_read_b64_tr_b16 v[76:77], v139 offset:0
  ds_read_b64_tr_b16 v[78:79], v139 offset:512
  ds_read_b128 v[56:59], v116 offset:0
  s_waitcnt lgkmcnt(15)
  v_mfma_f32_32x32x16_bf16 v[24:39], v[80:83], v[60:63], v[24:39]
  v_mfma_f32_32x32x16_bf16 v[40:55], v[84:87], v[60:63], v[40:55]
  ds_read_b64_tr_b16 v[80:81], v138 offset:2048
  ds_read_b64_tr_b16 v[82:83], v138 offset:2560
  ds_read_b64_tr_b16 v[84:85], v139 offset:2048
  ds_read_b64_tr_b16 v[86:87], v139 offset:2560
  ds_read_b128 v[60:63], v117 offset:0
  s_waitcnt lgkmcnt(15)
  v_mfma_f32_32x32x16_bf16 v[24:39], v[88:91], v[64:67], v[24:39]
  v_mfma_f32_32x32x16_bf16 v[40:55], v[92:95], v[64:67], v[40:55]
  ds_read_b64_tr_b16 v[88:89], v138 offset:4096
  ds_read_b64_tr_b16 v[90:91], v138 offset:4608
  ds_read_b64_tr_b16 v[92:93], v139 offset:4096
  ds_read_b64_tr_b16 v[94:95], v139 offset:4608
  ds_read_b128 v[64:67], v118 offset:0
  s_waitcnt lgkmcnt(15)
  v_mfma_f32_32x32x16_bf16 v[24:39], v[96:99], v[68:71], v[24:39]
  v_mfma_f32_32x32x16_bf16 v[40:55], v[100:103], v[68:71], v[40:55]
  s_barrier
  ds_read_b64_tr_b16 v[96:97], v138 offset:6144
  ds_read_b64_tr_b16 v[98:99], v138 offset:6656
  ds_read_b64_tr_b16 v[100:101], v139 offset:6144
  ds_read_b64_tr_b16 v[102:103], v139 offset:6656
  ds_read_b128 v[68:71], v119 offset:0
  s_waitcnt lgkmcnt(15)
  v_mfma_f32_32x32x16_bf16 v[24:39], v[72:75], v[56:59], v[24:39]
  v_mfma_f32_32x32x16_bf16 v[40:55], v[76:79], v[56:59], v[40:55]
  ds_read_b64_tr_b16 v[72:73], v140 offset:0
  ds_read_b64_tr_b16 v[74:75], v140 offset:512
  ds_read_b64_tr_b16 v[76:77], v141 offset:0
  ds_read_b64_tr_b16 v[78:79], v141 offset:512
  ds_read_b128 v[56:59], v120 offset:0
  s_waitcnt lgkmcnt(15)
  v_mfma_f32_32x32x16_bf16 v[24:39], v[80:83], v[60:63], v[24:39]
  v_mfma_f32_32x32x16_bf16 v[40:55], v[84:87], v[60:63], v[40:55]
  ds_read_b64_tr_b16 v[80:81], v140 offset:2048
  ds_read_b64_tr_b16 v[82:83], v140 offset:2560
  ds_read_b64_tr_b16 v[84:85], v141 offset:2048
  ds_read_b64_tr_b16 v[86:87], v141 offset:2560
  ds_read_b128 v[60:63], v121 offset:0
  s_waitcnt lgkmcnt(15)
  v_mfma_f32_32x32x16_bf16 v[24:39], v[88:91], v[64:67], v[24:39]
  v_mfma_f32_32x32x16_bf16 v[40:55], v[92:95], v[64:67], v[40:55]
  ds_read_b64_tr_b16 v[88:89], v140 offset:4096
  ds_read_b64_tr_b16 v[90:91], v140 offset:4608
  ds_read_b64_tr_b16 v[92:93], v141 offset:4096
  ds_read_b64_tr_b16 v[94:95], v141 offset:4608
  ds_read_b128 v[64:67], v122 offset:0
  s_waitcnt lgkmcnt(15)
  v_mfma_f32_32x32x16_bf16 v[24:39], v[96:99], v[68:71], v[24:39]
  v_mfma_f32_32x32x16_bf16 v[40:55], v[100:103], v[68:71], v[40:55]
  s_barrier
  ds_read_b64_tr_b16 v[96:97], v140 offset:6144
  ds_read_b64_tr_b16 v[98:99], v140 offset:6656
  ds_read_b64_tr_b16 v[100:101], v141 offset:6144
  ds_read_b64_tr_b16 v[102:103], v141 offset:6656
  ds_read_b128 v[68:71], v123 offset:0
  s_waitcnt lgkmcnt(15)
  v_mfma_f32_32x32x16_bf16 v[24:39], v[72:75], v[56:59], v[24:39]
  v_mfma_f32_32x32x16_bf16 v[40:55], v[76:79], v[56:59], v[40:55]
  ds_read_b64_tr_b16 v[72:73], v142 offset:0
  ds_read_b64_tr_b16 v[74:75], v142 offset:512
  ds_read_b64_tr_b16 v[76:77], v143 offset:0
  ds_read_b64_tr_b16 v[78:79], v143 offset:512
  ds_read_b128 v[56:59], v124 offset:0
  s_waitcnt lgkmcnt(15)
  v_mfma_f32_32x32x16_bf16 v[24:39], v[80:83], v[60:63], v[24:39]
  v_mfma_f32_32x32x16_bf16 v[40:55], v[84:87], v[60:63], v[40:55]
  ds_read_b64_tr_b16 v[80:81], v142 offset:2048
  ds_read_b64_tr_b16 v[82:83], v142 offset:2560
  ds_read_b64_tr_b16 v[84:85], v143 offset:2048
  ds_read_b64_tr_b16 v[86:87], v143 offset:2560
  ds_read_b128 v[60:63], v125 offset:0
  s_waitcnt lgkmcnt(15)
  v_mfma_f32_32x32x16_bf16 v[24:39], v[88:91], v[64:67], v[24:39]
  v_mfma_f32_32x32x16_bf16 v[40:55], v[92:95], v[64:67], v[40:55]
  ds_read_b64_tr_b16 v[88:89], v142 offset:4096
  ds_read_b64_tr_b16 v[90:91], v142 offset:4608
  ds_read_b64_tr_b16 v[92:93], v143 offset:4096
  ds_read_b64_tr_b16 v[94:95], v143 offset:4608
  ds_read_b128 v[64:67], v126 offset:0
  s_waitcnt lgkmcnt(15)
  v_mfma_f32_32x32x16_bf16 v[24:39], v[96:99], v[68:71], v[24:39]
  v_mfma_f32_32x32x16_bf16 v[40:55], v[100:103], v[68:71], v[40:55]
  s_barrier
  ds_read_b64_tr_b16 v[96:97], v142 offset:6144
  ds_read_b64_tr_b16 v[98:99], v142 offset:6656
  ds_read_b64_tr_b16 v[100:101], v143 offset:6144
  ds_read_b64_tr_b16 v[102:103], v143 offset:6656
  ds_read_b128 v[68:71], v127 offset:0
  s_waitcnt lgkmcnt(15)
  v_mfma_f32_32x32x16_bf16 v[24:39], v[72:75], v[56:59], v[24:39]
  v_mfma_f32_32x32x16_bf16 v[40:55], v[76:79], v[56:59], v[40:55]
  ds_read_b64_tr_b16 v[72:73], v136 offset:0
  ds_read_b64_tr_b16 v[74:75], v136 offset:512
  ds_read_b64_tr_b16 v[76:77], v137 offset:0
  ds_read_b64_tr_b16 v[78:79], v137 offset:512
  ds_read_b128 v[56:59], v128 offset:0
  s_waitcnt lgkmcnt(15)
  v_mfma_f32_32x32x16_bf16 v[24:39], v[80:83], v[60:63], v[24:39]
  v_mfma_f32_32x32x16_bf16 v[40:55], v[84:87], v[60:63], v[40:55]
  ds_read_b64_tr_b16 v[80:81], v136 offset:2048
  ds_read_b64_tr_b16 v[82:83], v136 offset:2560
  ds_read_b64_tr_b16 v[84:85], v137 offset:2048
  ds_read_b64_tr_b16 v[86:87], v137 offset:2560
  ds_read_b128 v[60:63], v129 offset:0
  s_waitcnt lgkmcnt(15)
  v_mfma_f32_32x32x16_bf16 v[24:39], v[88:91], v[64:67], v[24:39]
  v_mfma_f32_32x32x16_bf16 v[40:55], v[92:95], v[64:67], v[40:55]
  ds_read_b64_tr_b16 v[88:89], v136 offset:4096
  ds_read_b64_tr_b16 v[90:91], v136 offset:4608
  ds_read_b64_tr_b16 v[92:93], v137 offset:4096
  ds_read_b64_tr_b16 v[94:95], v137 offset:4608
  ds_read_b128 v[64:67], v130 offset:0
  s_waitcnt lgkmcnt(15)
  v_mfma_f32_32x32x16_bf16 v[24:39], v[96:99], v[68:71], v[24:39]
  v_mfma_f32_32x32x16_bf16 v[40:55], v[100:103], v[68:71], v[40:55]
  s_barrier
  ds_read_b64_tr_b16 v[96:97], v136 offset:6144
  ds_read_b64_tr_b16 v[98:99], v136 offset:6656
  ds_read_b64_tr_b16 v[100:101], v137 offset:6144
  ds_read_b64_tr_b16 v[102:103], v137 offset:6656
  ds_read_b128 v[68:71], v131 offset:0
  s_waitcnt lgkmcnt(15)
  v_mfma_f32_32x32x16_bf16 v[24:39], v[72:75], v[56:59], v[24:39]
  v_mfma_f32_32x32x16_bf16 v[40:55], v[76:79], v[56:59], v[40:55]
  ds_read_b64_tr_b16 v[72:73], v138 offset:0
  ds_read_b64_tr_b16 v[74:75], v138 offset:512
  ds_read_b64_tr_b16 v[76:77], v139 offset:0
  ds_read_b64_tr_b16 v[78:79], v139 offset:512
  ds_read_b128 v[56:59], v132 offset:0
  s_waitcnt lgkmcnt(15)
  v_mfma_f32_32x32x16_bf16 v[24:39], v[80:83], v[60:63], v[24:39]
  v_mfma_f32_32x32x16_bf16 v[40:55], v[84:87], v[60:63], v[40:55]
  ds_read_b64_tr_b16 v[80:81], v138 offset:2048
  ds_read_b64_tr_b16 v[82:83], v138 offset:2560
  ds_read_b64_tr_b16 v[84:85], v139 offset:2048
  ds_read_b64_tr_b16 v[86:87], v139 offset:2560
  ds_read_b128 v[60:63], v133 offset:0
  s_waitcnt lgkmcnt(15)
  v_mfma_f32_32x32x16_bf16 v[24:39], v[88:91], v[64:67], v[24:39]
  v_mfma_f32_32x32x16_bf16 v[40:55], v[92:95], v[64:67], v[40:55]
  ds_read_b64_tr_b16 v[88:89], v138 offset:4096
  ds_read_b64_tr_b16 v[90:91], v138 offset:4608
  ds_read_b64_tr_b16 v[92:93], v139 offset:4096
  ds_read_b64_tr_b16 v[94:95], v139 offset:4608
  ds_read_b128 v[64:67], v134 offset:0
  s_waitcnt lgkmcnt(15)
  v_mfma_f32_32x32x16_bf16 v[24:39], v[96:99], v[68:71], v[24:39]
  v_mfma_f32_32x32x16_bf16 v[40:55], v[100:103], v[68:71], v[40:55]
  s_barrier
  ds_read_b64_tr_b16 v[96:97], v138 offset:6144
  ds_read_b64_tr_b16 v[98:99], v138 offset:6656
  ds_read_b64_tr_b16 v[100:101], v139 offset:6144
  ds_read_b64_tr_b16 v[102:103], v139 offset:6656
  ds_read_b128 v[68:71], v135 offset:0
  s_waitcnt lgkmcnt(15)
  v_mfma_f32_32x32x16_bf16 v[24:39], v[72:75], v[56:59], v[24:39]
  v_mfma_f32_32x32x16_bf16 v[40:55], v[76:79], v[56:59], v[40:55]
  ds_read_b64_tr_b16 v[72:73], v140 offset:0
  ds_read_b64_tr_b16 v[74:75], v140 offset:512
  ds_read_b64_tr_b16 v[76:77], v141 offset:0
  ds_read_b64_tr_b16 v[78:79], v141 offset:512
  ds_read_b128 v[56:59], v108 offset:0
  s_waitcnt lgkmcnt(15)
  v_mfma_f32_32x32x16_bf16 v[24:39], v[80:83], v[60:63], v[24:39]
  v_mfma_f32_32x32x16_bf16 v[40:55], v[84:87], v[60:63], v[40:55]
  ds_read_b64_tr_b16 v[80:81], v140 offset:2048
  ds_read_b64_tr_b16 v[82:83], v140 offset:2560
  ds_read_b64_tr_b16 v[84:85], v141 offset:2048
  ds_read_b64_tr_b16 v[86:87], v141 offset:2560
  ds_read_b128 v[60:63], v109 offset:0
  s_waitcnt lgkmcnt(15)
  v_mfma_f32_32x32x16_bf16 v[24:39], v[88:91], v[64:67], v[24:39]
  v_mfma_f32_32x32x16_bf16 v[40:55], v[92:95], v[64:67], v[40:55]
  ds_read_b64_tr_b16 v[88:89], v140 offset:4096
  ds_read_b64_tr_b16 v[90:91], v140 offset:4608
  ds_read_b64_tr_b16 v[92:93], v141 offset:4096
  ds_read_b64_tr_b16 v[94:95], v141 offset:4608
  ds_read_b128 v[64:67], v110 offset:0
  s_waitcnt lgkmcnt(15)
  v_mfma_f32_32x32x16_bf16 v[24:39], v[96:99], v[68:71], v[24:39]
  v_mfma_f32_32x32x16_bf16 v[40:55], v[100:103], v[68:71], v[40:55]
  s_barrier
  ds_read_b64_tr_b16 v[96:97], v140 offset:6144
  ds_read_b64_tr_b16 v[98:99], v140 offset:6656
  ds_read_b64_tr_b16 v[100:101], v141 offset:6144
  ds_read_b64_tr_b16 v[102:103], v141 offset:6656
  ds_read_b128 v[68:71], v111 offset:0
  s_waitcnt lgkmcnt(15)
  v_mfma_f32_32x32x16_bf16 v[24:39], v[72:75], v[56:59], v[24:39]
  v_mfma_f32_32x32x16_bf16 v[40:55], v[76:79], v[56:59], v[40:55]
  ds_read_b64_tr_b16 v[72:73], v142 offset:0
  ds_read_b64_tr_b16 v[74:75], v142 offset:512
  ds_read_b64_tr_b16 v[76:77], v143 offset:0
  ds_read_b64_tr_b16 v[78:79], v143 offset:512
  ds_read_b128 v[56:59], v112 offset:0
  s_waitcnt lgkmcnt(15)
  v_mfma_f32_32x32x16_bf16 v[24:39], v[80:83], v[60:63], v[24:39]
  v_mfma_f32_32x32x16_bf16 v[40:55], v[84:87], v[60:63], v[40:55]
  ds_read_b64_tr_b16 v[80:81], v142 offset:2048
  ds_read_b64_tr_b16 v[82:83], v142 offset:2560
  ds_read_b64_tr_b16 v[84:85], v143 offset:2048
  ds_read_b64_tr_b16 v[86:87], v143 offset:2560
  ds_read_b128 v[60:63], v113 offset:0
  s_waitcnt lgkmcnt(15)
  v_mfma_f32_32x32x16_bf16 v[24:39], v[88:91], v[64:67], v[24:39]
  v_mfma_f32_32x32x16_bf16 v[40:55], v[92:95], v[64:67], v[40:55]
  ds_read_b64_tr_b16 v[88:89], v142 offset:4096
  ds_read_b64_tr_b16 v[90:91], v142 offset:4608
  ds_read_b64_tr_b16 v[92:93], v143 offset:4096
  ds_read_b64_tr_b16 v[94:95], v143 offset:4608
  ds_read_b128 v[64:67], v114 offset:0
  s_waitcnt lgkmcnt(15)
  v_mfma_f32_32x32x16_bf16 v[24:39], v[96:99], v[68:71], v[24:39]
  v_mfma_f32_32x32x16_bf16 v[40:55], v[100:103], v[68:71], v[40:55]
  s_barrier
  ds_read_b64_tr_b16 v[96:97], v142 offset:6144
  ds_read_b64_tr_b16 v[98:99], v142 offset:6656
  ds_read_b64_tr_b16 v[100:101], v143 offset:6144
  ds_read_b64_tr_b16 v[102:103], v143 offset:6656
  ds_read_b128 v[68:71], v115 offset:0
  s_waitcnt lgkmcnt(15)
  v_mfma_f32_32x32x16_bf16 v[24:39], v[72:75], v[56:59], v[24:39]
  v_mfma_f32_32x32x16_bf16 v[40:55], v[76:79], v[56:59], v[40:55]
  ds_read_b64_tr_b16 v[72:73], v136 offset:0
  ds_read_b64_tr_b16 v[74:75], v136 offset:512
  ds_read_b64_tr_b16 v[76:77], v137 offset:0
  ds_read_b64_tr_b16 v[78:79], v137 offset:512
  ds_read_b128 v[56:59], v116 offset:0
  s_waitcnt lgkmcnt(15)
  v_mfma_f32_32x32x16_bf16 v[24:39], v[80:83], v[60:63], v[24:39]
  v_mfma_f32_32x32x16_bf16 v[40:55], v[84:87], v[60:63], v[40:55]
  ds_read_b64_tr_b16 v[80:81], v136 offset:2048
  ds_read_b64_tr_b16 v[82:83], v136 offset:2560
  ds_read_b64_tr_b16 v[84:85], v137 offset:2048
  ds_read_b64_tr_b16 v[86:87], v137 offset:2560
  ds_read_b128 v[60:63], v117 offset:0
  s_waitcnt lgkmcnt(15)
  v_mfma_f32_32x32x16_bf16 v[24:39], v[88:91], v[64:67], v[24:39]
  v_mfma_f32_32x32x16_bf16 v[40:55], v[92:95], v[64:67], v[40:55]
  ds_read_b64_tr_b16 v[88:89], v136 offset:4096
  ds_read_b64_tr_b16 v[90:91], v136 offset:4608
  ds_read_b64_tr_b16 v[92:93], v137 offset:4096
  ds_read_b64_tr_b16 v[94:95], v137 offset:4608
  ds_read_b128 v[64:67], v118 offset:0
  s_waitcnt lgkmcnt(15)
  v_mfma_f32_32x32x16_bf16 v[24:39], v[96:99], v[68:71], v[24:39]
  v_mfma_f32_32x32x16_bf16 v[40:55], v[100:103], v[68:71], v[40:55]
  s_barrier
  ds_read_b64_tr_b16 v[96:97], v136 offset:6144
  ds_read_b64_tr_b16 v[98:99], v136 offset:6656
  ds_read_b64_tr_b16 v[100:101], v137 offset:6144
  ds_read_b64_tr_b16 v[102:103], v137 offset:6656
  ds_read_b128 v[68:71], v119 offset:0
  s_waitcnt lgkmcnt(15)
  v_mfma_f32_32x32x16_bf16 v[24:39], v[72:75], v[56:59], v[24:39]
  v_mfma_f32_32x32x16_bf16 v[40:55], v[76:79], v[56:59], v[40:55]
  ds_read_b64_tr_b16 v[72:73], v138 offset:0
  ds_read_b64_tr_b16 v[74:75], v138 offset:512
  ds_read_b64_tr_b16 v[76:77], v139 offset:0
  ds_read_b64_tr_b16 v[78:79], v139 offset:512
  ds_read_b128 v[56:59], v120 offset:0
  s_waitcnt lgkmcnt(15)
  v_mfma_f32_32x32x16_bf16 v[24:39], v[80:83], v[60:63], v[24:39]
  v_mfma_f32_32x32x16_bf16 v[40:55], v[84:87], v[60:63], v[40:55]
  ds_read_b64_tr_b16 v[80:81], v138 offset:2048
  ds_read_b64_tr_b16 v[82:83], v138 offset:2560
  ds_read_b64_tr_b16 v[84:85], v139 offset:2048
  ds_read_b64_tr_b16 v[86:87], v139 offset:2560
  ds_read_b128 v[60:63], v121 offset:0
  s_waitcnt lgkmcnt(15)
  v_mfma_f32_32x32x16_bf16 v[24:39], v[88:91], v[64:67], v[24:39]
  v_mfma_f32_32x32x16_bf16 v[40:55], v[92:95], v[64:67], v[40:55]
  ds_read_b64_tr_b16 v[88:89], v138 offset:4096
  ds_read_b64_tr_b16 v[90:91], v138 offset:4608
  ds_read_b64_tr_b16 v[92:93], v139 offset:4096
  ds_read_b64_tr_b16 v[94:95], v139 offset:4608
  ds_read_b128 v[64:67], v122 offset:0
  s_waitcnt lgkmcnt(15)
  v_mfma_f32_32x32x16_bf16 v[24:39], v[96:99], v[68:71], v[24:39]
  v_mfma_f32_32x32x16_bf16 v[40:55], v[100:103], v[68:71], v[40:55]
  s_barrier
  ds_read_b64_tr_b16 v[96:97], v138 offset:6144
  ds_read_b64_tr_b16 v[98:99], v138 offset:6656
  ds_read_b64_tr_b16 v[100:101], v139 offset:6144
  ds_read_b64_tr_b16 v[102:103], v139 offset:6656
  ds_read_b128 v[68:71], v123 offset:0
  s_waitcnt lgkmcnt(15)
  v_mfma_f32_32x32x16_bf16 v[24:39], v[72:75], v[56:59], v[24:39]
  v_mfma_f32_32x32x16_bf16 v[40:55], v[76:79], v[56:59], v[40:55]
  ds_read_b64_tr_b16 v[72:73], v140 offset:0
  ds_read_b64_tr_b16 v[74:75], v140 offset:512
  ds_read_b64_tr_b16 v[76:77], v141 offset:0
  ds_read_b64_tr_b16 v[78:79], v141 offset:512
  ds_read_b128 v[56:59], v124 offset:0
  s_waitcnt lgkmcnt(15)
  v_mfma_f32_32x32x16_bf16 v[24:39], v[80:83], v[60:63], v[24:39]
  v_mfma_f32_32x32x16_bf16 v[40:55], v[84:87], v[60:63], v[40:55]
  ds_read_b64_tr_b16 v[80:81], v140 offset:2048
  ds_read_b64_tr_b16 v[82:83], v140 offset:2560
  ds_read_b64_tr_b16 v[84:85], v141 offset:2048
  ds_read_b64_tr_b16 v[86:87], v141 offset:2560
  ds_read_b128 v[60:63], v125 offset:0
  s_waitcnt lgkmcnt(15)
  v_mfma_f32_32x32x16_bf16 v[24:39], v[88:91], v[64:67], v[24:39]
  v_mfma_f32_32x32x16_bf16 v[40:55], v[92:95], v[64:67], v[40:55]
  ds_read_b64_tr_b16 v[88:89], v140 offset:4096
  ds_read_b64_tr_b16 v[90:91], v140 offset:4608
  ds_read_b64_tr_b16 v[92:93], v141 offset:4096
  ds_read_b64_tr_b16 v[94:95], v141 offset:4608
  ds_read_b128 v[64:67], v126 offset:0
  s_waitcnt lgkmcnt(15)
  v_mfma_f32_32x32x16_bf16 v[24:39], v[96:99], v[68:71], v[24:39]
  v_mfma_f32_32x32x16_bf16 v[40:55], v[100:103], v[68:71], v[40:55]
  s_barrier
  ds_read_b64_tr_b16 v[96:97], v140 offset:6144
  ds_read_b64_tr_b16 v[98:99], v140 offset:6656
  ds_read_b64_tr_b16 v[100:101], v141 offset:6144
  ds_read_b64_tr_b16 v[102:103], v141 offset:6656
  ds_read_b128 v[68:71], v127 offset:0
  s_waitcnt lgkmcnt(15)
  v_mfma_f32_32x32x16_bf16 v[24:39], v[72:75], v[56:59], v[24:39]
  v_mfma_f32_32x32x16_bf16 v[40:55], v[76:79], v[56:59], v[40:55]
  ds_read_b64_tr_b16 v[72:73], v142 offset:0
  ds_read_b64_tr_b16 v[74:75], v142 offset:512
  ds_read_b64_tr_b16 v[76:77], v143 offset:0
  ds_read_b64_tr_b16 v[78:79], v143 offset:512
  ds_read_b128 v[56:59], v128 offset:0
  s_waitcnt lgkmcnt(15)
  v_mfma_f32_32x32x16_bf16 v[24:39], v[80:83], v[60:63], v[24:39]
  v_mfma_f32_32x32x16_bf16 v[40:55], v[84:87], v[60:63], v[40:55]
  ds_read_b64_tr_b16 v[80:81], v142 offset:2048
  ds_read_b64_tr_b16 v[82:83], v142 offset:2560
  ds_read_b64_tr_b16 v[84:85], v143 offset:2048
  ds_read_b64_tr_b16 v[86:87], v143 offset:2560
  ds_read_b128 v[60:63], v129 offset:0
  s_waitcnt lgkmcnt(15)
  v_mfma_f32_32x32x16_bf16 v[24:39], v[88:91], v[64:67], v[24:39]
  v_mfma_f32_32x32x16_bf16 v[40:55], v[92:95], v[64:67], v[40:55]
  ds_read_b64_tr_b16 v[88:89], v142 offset:4096
  ds_read_b64_tr_b16 v[90:91], v142 offset:4608
  ds_read_b64_tr_b16 v[92:93], v143 offset:4096
  ds_read_b64_tr_b16 v[94:95], v143 offset:4608
  ds_read_b128 v[64:67], v130 offset:0
  s_waitcnt lgkmcnt(15)
  v_mfma_f32_32x32x16_bf16 v[24:39], v[96:99], v[68:71], v[24:39]
  v_mfma_f32_32x32x16_bf16 v[40:55], v[100:103], v[68:71], v[40:55]
  s_barrier
  ds_read_b64_tr_b16 v[96:97], v142 offset:6144
  ds_read_b64_tr_b16 v[98:99], v142 offset:6656
  ds_read_b64_tr_b16 v[100:101], v143 offset:6144
  ds_read_b64_tr_b16 v[102:103], v143 offset:6656
  ds_read_b128 v[68:71], v131 offset:0
  s_waitcnt lgkmcnt(15)
  v_mfma_f32_32x32x16_bf16 v[24:39], v[72:75], v[56:59], v[24:39]
  v_mfma_f32_32x32x16_bf16 v[40:55], v[76:79], v[56:59], v[40:55]
  ds_read_b64_tr_b16 v[72:73], v136 offset:0
  ds_read_b64_tr_b16 v[74:75], v136 offset:512
  ds_read_b64_tr_b16 v[76:77], v137 offset:0
  ds_read_b64_tr_b16 v[78:79], v137 offset:512
  ds_read_b128 v[56:59], v132 offset:0
  s_waitcnt lgkmcnt(15)
  v_mfma_f32_32x32x16_bf16 v[24:39], v[80:83], v[60:63], v[24:39]
  v_mfma_f32_32x32x16_bf16 v[40:55], v[84:87], v[60:63], v[40:55]
  ds_read_b64_tr_b16 v[80:81], v136 offset:2048
  ds_read_b64_tr_b16 v[82:83], v136 offset:2560
  ds_read_b64_tr_b16 v[84:85], v137 offset:2048
  ds_read_b64_tr_b16 v[86:87], v137 offset:2560
  ds_read_b128 v[60:63], v133 offset:0
  s_waitcnt lgkmcnt(15)
  v_mfma_f32_32x32x16_bf16 v[24:39], v[88:91], v[64:67], v[24:39]
  v_mfma_f32_32x32x16_bf16 v[40:55], v[92:95], v[64:67], v[40:55]
  ds_read_b64_tr_b16 v[88:89], v136 offset:4096
  ds_read_b64_tr_b16 v[90:91], v136 offset:4608
  ds_read_b64_tr_b16 v[92:93], v137 offset:4096
  ds_read_b64_tr_b16 v[94:95], v137 offset:4608
  ds_read_b128 v[64:67], v134 offset:0
  s_waitcnt lgkmcnt(15)
  v_mfma_f32_32x32x16_bf16 v[24:39], v[96:99], v[68:71], v[24:39]
  v_mfma_f32_32x32x16_bf16 v[40:55], v[100:103], v[68:71], v[40:55]
  s_barrier
  ds_read_b64_tr_b16 v[96:97], v136 offset:6144
  ds_read_b64_tr_b16 v[98:99], v136 offset:6656
  ds_read_b64_tr_b16 v[100:101], v137 offset:6144
  ds_read_b64_tr_b16 v[102:103], v137 offset:6656
  ds_read_b128 v[68:71], v135 offset:0
  s_waitcnt lgkmcnt(15)
  v_mfma_f32_32x32x16_bf16 v[24:39], v[72:75], v[56:59], v[24:39]
  v_mfma_f32_32x32x16_bf16 v[40:55], v[76:79], v[56:59], v[40:55]
  ds_read_b64_tr_b16 v[72:73], v138 offset:0
  ds_read_b64_tr_b16 v[74:75], v138 offset:512
  ds_read_b64_tr_b16 v[76:77], v139 offset:0
  ds_read_b64_tr_b16 v[78:79], v139 offset:512
  ds_read_b128 v[56:59], v108 offset:0
  s_waitcnt lgkmcnt(15)
  v_mfma_f32_32x32x16_bf16 v[24:39], v[80:83], v[60:63], v[24:39]
  v_mfma_f32_32x32x16_bf16 v[40:55], v[84:87], v[60:63], v[40:55]
  ds_read_b64_tr_b16 v[80:81], v138 offset:2048
  ds_read_b64_tr_b16 v[82:83], v138 offset:2560
  ds_read_b64_tr_b16 v[84:85], v139 offset:2048
  ds_read_b64_tr_b16 v[86:87], v139 offset:2560
  ds_read_b128 v[60:63], v109 offset:0
  s_waitcnt lgkmcnt(15)
  v_mfma_f32_32x32x16_bf16 v[24:39], v[88:91], v[64:67], v[24:39]
  v_mfma_f32_32x32x16_bf16 v[40:55], v[92:95], v[64:67], v[40:55]
  ds_read_b64_tr_b16 v[88:89], v138 offset:4096
  ds_read_b64_tr_b16 v[90:91], v138 offset:4608
  ds_read_b64_tr_b16 v[92:93], v139 offset:4096
  ds_read_b64_tr_b16 v[94:95], v139 offset:4608
  ds_read_b128 v[64:67], v110 offset:0
  s_waitcnt lgkmcnt(15)
  v_mfma_f32_32x32x16_bf16 v[24:39], v[96:99], v[68:71], v[24:39]
  v_mfma_f32_32x32x16_bf16 v[40:55], v[100:103], v[68:71], v[40:55]
  s_barrier
  ds_read_b64_tr_b16 v[96:97], v138 offset:6144
  ds_read_b64_tr_b16 v[98:99], v138 offset:6656
  ds_read_b64_tr_b16 v[100:101], v139 offset:6144
  ds_read_b64_tr_b16 v[102:103], v139 offset:6656
  ds_read_b128 v[68:71], v111 offset:0
  s_waitcnt lgkmcnt(15)
  v_mfma_f32_32x32x16_bf16 v[24:39], v[72:75], v[56:59], v[24:39]
  v_mfma_f32_32x32x16_bf16 v[40:55], v[76:79], v[56:59], v[40:55]
  ds_read_b64_tr_b16 v[72:73], v140 offset:0
  ds_read_b64_tr_b16 v[74:75], v140 offset:512
  ds_read_b64_tr_b16 v[76:77], v141 offset:0
  ds_read_b64_tr_b16 v[78:79], v141 offset:512
  ds_read_b128 v[56:59], v112 offset:0
  s_waitcnt lgkmcnt(15)
  v_mfma_f32_32x32x16_bf16 v[24:39], v[80:83], v[60:63], v[24:39]
  v_mfma_f32_32x32x16_bf16 v[40:55], v[84:87], v[60:63], v[40:55]
  ds_read_b64_tr_b16 v[80:81], v140 offset:2048
  ds_read_b64_tr_b16 v[82:83], v140 offset:2560
  ds_read_b64_tr_b16 v[84:85], v141 offset:2048
  ds_read_b64_tr_b16 v[86:87], v141 offset:2560
  ds_read_b128 v[60:63], v113 offset:0
  s_waitcnt lgkmcnt(15)
  v_mfma_f32_32x32x16_bf16 v[24:39], v[88:91], v[64:67], v[24:39]
  v_mfma_f32_32x32x16_bf16 v[40:55], v[92:95], v[64:67], v[40:55]
  ds_read_b64_tr_b16 v[88:89], v140 offset:4096
  ds_read_b64_tr_b16 v[90:91], v140 offset:4608
  ds_read_b64_tr_b16 v[92:93], v141 offset:4096
  ds_read_b64_tr_b16 v[94:95], v141 offset:4608
  ds_read_b128 v[64:67], v114 offset:0
  s_waitcnt lgkmcnt(15)
  v_mfma_f32_32x32x16_bf16 v[24:39], v[96:99], v[68:71], v[24:39]
  v_mfma_f32_32x32x16_bf16 v[40:55], v[100:103], v[68:71], v[40:55]
  s_barrier
  ds_read_b64_tr_b16 v[96:97], v140 offset:6144
  ds_read_b64_tr_b16 v[98:99], v140 offset:6656
  ds_read_b64_tr_b16 v[100:101], v141 offset:6144
  ds_read_b64_tr_b16 v[102:103], v141 offset:6656
  ds_read_b128 v[68:71], v115 offset:0
  s_waitcnt lgkmcnt(15)
  v_mfma_f32_32x32x16_bf16 v[24:39], v[72:75], v[56:59], v[24:39]
  v_mfma_f32_32x32x16_bf16 v[40:55], v[76:79], v[56:59], v[40:55]
  ds_read_b64_tr_b16 v[72:73], v142 offset:0
  ds_read_b64_tr_b16 v[74:75], v142 offset:512
  ds_read_b64_tr_b16 v[76:77], v143 offset:0
  ds_read_b64_tr_b16 v[78:79], v143 offset:512
  ds_read_b128 v[56:59], v116 offset:0
  s_waitcnt lgkmcnt(15)
  v_mfma_f32_32x32x16_bf16 v[24:39], v[80:83], v[60:63], v[24:39]
  v_mfma_f32_32x32x16_bf16 v[40:55], v[84:87], v[60:63], v[40:55]
  ds_read_b64_tr_b16 v[80:81], v142 offset:2048
  ds_read_b64_tr_b16 v[82:83], v142 offset:2560
  ds_read_b64_tr_b16 v[84:85], v143 offset:2048
  ds_read_b64_tr_b16 v[86:87], v143 offset:2560
  ds_read_b128 v[60:63], v117 offset:0
  s_waitcnt lgkmcnt(15)
  v_mfma_f32_32x32x16_bf16 v[24:39], v[88:91], v[64:67], v[24:39]
  v_mfma_f32_32x32x16_bf16 v[40:55], v[92:95], v[64:67], v[40:55]
  ds_read_b64_tr_b16 v[88:89], v142 offset:4096
  ds_read_b64_tr_b16 v[90:91], v142 offset:4608
  ds_read_b64_tr_b16 v[92:93], v143 offset:4096
  ds_read_b64_tr_b16 v[94:95], v143 offset:4608
  ds_read_b128 v[64:67], v118 offset:0
  s_waitcnt lgkmcnt(15)
  v_mfma_f32_32x32x16_bf16 v[24:39], v[96:99], v[68:71], v[24:39]
  v_mfma_f32_32x32x16_bf16 v[40:55], v[100:103], v[68:71], v[40:55]
  s_barrier
  ds_read_b64_tr_b16 v[96:97], v142 offset:6144
  ds_read_b64_tr_b16 v[98:99], v142 offset:6656
  ds_read_b64_tr_b16 v[100:101], v143 offset:6144
  ds_read_b64_tr_b16 v[102:103], v143 offset:6656
  ds_read_b128 v[68:71], v119 offset:0
  s_waitcnt lgkmcnt(15)
  v_mfma_f32_32x32x16_bf16 v[24:39], v[72:75], v[56:59], v[24:39]
  v_mfma_f32_32x32x16_bf16 v[40:55], v[76:79], v[56:59], v[40:55]
  ds_read_b64_tr_b16 v[72:73], v136 offset:0
  ds_read_b64_tr_b16 v[74:75], v136 offset:512
  ds_read_b64_tr_b16 v[76:77], v137 offset:0
  ds_read_b64_tr_b16 v[78:79], v137 offset:512
  ds_read_b128 v[56:59], v120 offset:0
  s_waitcnt lgkmcnt(15)
  v_mfma_f32_32x32x16_bf16 v[24:39], v[80:83], v[60:63], v[24:39]
  v_mfma_f32_32x32x16_bf16 v[40:55], v[84:87], v[60:63], v[40:55]
  ds_read_b64_tr_b16 v[80:81], v136 offset:2048
  ds_read_b64_tr_b16 v[82:83], v136 offset:2560
  ds_read_b64_tr_b16 v[84:85], v137 offset:2048
  ds_read_b64_tr_b16 v[86:87], v137 offset:2560
  ds_read_b128 v[60:63], v121 offset:0
  s_waitcnt lgkmcnt(15)
  v_mfma_f32_32x32x16_bf16 v[24:39], v[88:91], v[64:67], v[24:39]
  v_mfma_f32_32x32x16_bf16 v[40:55], v[92:95], v[64:67], v[40:55]
  ds_read_b64_tr_b16 v[88:89], v136 offset:4096
  ds_read_b64_tr_b16 v[90:91], v136 offset:4608
  ds_read_b64_tr_b16 v[92:93], v137 offset:4096
  ds_read_b64_tr_b16 v[94:95], v137 offset:4608
  ds_read_b128 v[64:67], v122 offset:0
  s_waitcnt lgkmcnt(15)
  v_mfma_f32_32x32x16_bf16 v[24:39], v[96:99], v[68:71], v[24:39]
  v_mfma_f32_32x32x16_bf16 v[40:55], v[100:103], v[68:71], v[40:55]
  s_barrier
  ds_read_b64_tr_b16 v[96:97], v136 offset:6144
  ds_read_b64_tr_b16 v[98:99], v136 offset:6656
  ds_read_b64_tr_b16 v[100:101], v137 offset:6144
  ds_read_b64_tr_b16 v[102:103], v137 offset:6656
  ds_read_b128 v[68:71], v123 offset:0
  s_waitcnt lgkmcnt(15)
  v_mfma_f32_32x32x16_bf16 v[24:39], v[72:75], v[56:59], v[24:39]
  v_mfma_f32_32x32x16_bf16 v[40:55], v[76:79], v[56:59], v[40:55]
  ds_read_b64_tr_b16 v[72:73], v138 offset:0
  ds_read_b64_tr_b16 v[74:75], v138 offset:512
  ds_read_b64_tr_b16 v[76:77], v139 offset:0
  ds_read_b64_tr_b16 v[78:79], v139 offset:512
  ds_read_b128 v[56:59], v124 offset:0
  s_waitcnt lgkmcnt(15)
  v_mfma_f32_32x32x16_bf16 v[24:39], v[80:83], v[60:63], v[24:39]
  v_mfma_f32_32x32x16_bf16 v[40:55], v[84:87], v[60:63], v[40:55]
  ds_read_b64_tr_b16 v[80:81], v138 offset:2048
  ds_read_b64_tr_b16 v[82:83], v138 offset:2560
  ds_read_b64_tr_b16 v[84:85], v139 offset:2048
  ds_read_b64_tr_b16 v[86:87], v139 offset:2560
  ds_read_b128 v[60:63], v125 offset:0
  s_waitcnt lgkmcnt(15)
  v_mfma_f32_32x32x16_bf16 v[24:39], v[88:91], v[64:67], v[24:39]
  v_mfma_f32_32x32x16_bf16 v[40:55], v[92:95], v[64:67], v[40:55]
  ds_read_b64_tr_b16 v[88:89], v138 offset:4096
  ds_read_b64_tr_b16 v[90:91], v138 offset:4608
  ds_read_b64_tr_b16 v[92:93], v139 offset:4096
  ds_read_b64_tr_b16 v[94:95], v139 offset:4608
  ds_read_b128 v[64:67], v126 offset:0
  s_waitcnt lgkmcnt(15)
  v_mfma_f32_32x32x16_bf16 v[24:39], v[96:99], v[68:71], v[24:39]
  v_mfma_f32_32x32x16_bf16 v[40:55], v[100:103], v[68:71], v[40:55]
  s_barrier
  ds_read_b64_tr_b16 v[96:97], v138 offset:6144
  ds_read_b64_tr_b16 v[98:99], v138 offset:6656
  ds_read_b64_tr_b16 v[100:101], v139 offset:6144
  ds_read_b64_tr_b16 v[102:103], v139 offset:6656
  ds_read_b128 v[68:71], v127 offset:0
  s_waitcnt lgkmcnt(15)
  v_mfma_f32_32x32x16_bf16 v[24:39], v[72:75], v[56:59], v[24:39]
  v_mfma_f32_32x32x16_bf16 v[40:55], v[76:79], v[56:59], v[40:55]
  ds_read_b64_tr_b16 v[72:73], v140 offset:0
  ds_read_b64_tr_b16 v[74:75], v140 offset:512
  ds_read_b64_tr_b16 v[76:77], v141 offset:0
  ds_read_b64_tr_b16 v[78:79], v141 offset:512
  ds_read_b128 v[56:59], v128 offset:0
  s_waitcnt lgkmcnt(15)
  v_mfma_f32_32x32x16_bf16 v[24:39], v[80:83], v[60:63], v[24:39]
  v_mfma_f32_32x32x16_bf16 v[40:55], v[84:87], v[60:63], v[40:55]
  ds_read_b64_tr_b16 v[80:81], v140 offset:2048
  ds_read_b64_tr_b16 v[82:83], v140 offset:2560
  ds_read_b64_tr_b16 v[84:85], v141 offset:2048
  ds_read_b64_tr_b16 v[86:87], v141 offset:2560
  ds_read_b128 v[60:63], v129 offset:0
  s_waitcnt lgkmcnt(15)
  v_mfma_f32_32x32x16_bf16 v[24:39], v[88:91], v[64:67], v[24:39]
  v_mfma_f32_32x32x16_bf16 v[40:55], v[92:95], v[64:67], v[40:55]
  ds_read_b64_tr_b16 v[88:89], v140 offset:4096
  ds_read_b64_tr_b16 v[90:91], v140 offset:4608
  ds_read_b64_tr_b16 v[92:93], v141 offset:4096
  ds_read_b64_tr_b16 v[94:95], v141 offset:4608
  ds_read_b128 v[64:67], v130 offset:0
  s_waitcnt lgkmcnt(15)
  v_mfma_f32_32x32x16_bf16 v[24:39], v[96:99], v[68:71], v[24:39]
  v_mfma_f32_32x32x16_bf16 v[40:55], v[100:103], v[68:71], v[40:55]
  s_barrier
  ds_read_b64_tr_b16 v[96:97], v140 offset:6144
  ds_read_b64_tr_b16 v[98:99], v140 offset:6656
  ds_read_b64_tr_b16 v[100:101], v141 offset:6144
  ds_read_b64_tr_b16 v[102:103], v141 offset:6656
  ds_read_b128 v[68:71], v131 offset:0
  s_waitcnt lgkmcnt(15)
  v_mfma_f32_32x32x16_bf16 v[24:39], v[72:75], v[56:59], v[24:39]
  v_mfma_f32_32x32x16_bf16 v[40:55], v[76:79], v[56:59], v[40:55]
  ds_read_b64_tr_b16 v[72:73], v142 offset:0
  ds_read_b64_tr_b16 v[74:75], v142 offset:512
  ds_read_b64_tr_b16 v[76:77], v143 offset:0
  ds_read_b64_tr_b16 v[78:79], v143 offset:512
  ds_read_b128 v[56:59], v132 offset:0
  s_waitcnt lgkmcnt(15)
  v_mfma_f32_32x32x16_bf16 v[24:39], v[80:83], v[60:63], v[24:39]
  v_mfma_f32_32x32x16_bf16 v[40:55], v[84:87], v[60:63], v[40:55]
  ds_read_b64_tr_b16 v[80:81], v142 offset:2048
  ds_read_b64_tr_b16 v[82:83], v142 offset:2560
  ds_read_b64_tr_b16 v[84:85], v143 offset:2048
  ds_read_b64_tr_b16 v[86:87], v143 offset:2560
  ds_read_b128 v[60:63], v133 offset:0
  s_waitcnt lgkmcnt(15)
  v_mfma_f32_32x32x16_bf16 v[24:39], v[88:91], v[64:67], v[24:39]
  v_mfma_f32_32x32x16_bf16 v[40:55], v[92:95], v[64:67], v[40:55]
  ds_read_b64_tr_b16 v[88:89], v142 offset:4096
  ds_read_b64_tr_b16 v[90:91], v142 offset:4608
  ds_read_b64_tr_b16 v[92:93], v143 offset:4096
  ds_read_b64_tr_b16 v[94:95], v143 offset:4608
  ds_read_b128 v[64:67], v134 offset:0
  s_waitcnt lgkmcnt(15)
  v_mfma_f32_32x32x16_bf16 v[24:39], v[96:99], v[68:71], v[24:39]
  v_mfma_f32_32x32x16_bf16 v[40:55], v[100:103], v[68:71], v[40:55]
  s_barrier
  ds_read_b64_tr_b16 v[96:97], v142 offset:6144
  ds_read_b64_tr_b16 v[98:99], v142 offset:6656
  ds_read_b64_tr_b16 v[100:101], v143 offset:6144
  ds_read_b64_tr_b16 v[102:103], v143 offset:6656
  ds_read_b128 v[68:71], v135 offset:0
  s_waitcnt lgkmcnt(15)
  v_mfma_f32_32x32x16_bf16 v[24:39], v[72:75], v[56:59], v[24:39]
  v_mfma_f32_32x32x16_bf16 v[40:55], v[76:79], v[56:59], v[40:55]
  ds_read_b64_tr_b16 v[72:73], v136 offset:0
  ds_read_b64_tr_b16 v[74:75], v136 offset:512
  ds_read_b64_tr_b16 v[76:77], v137 offset:0
  ds_read_b64_tr_b16 v[78:79], v137 offset:512
  ds_read_b128 v[56:59], v108 offset:0
  s_waitcnt lgkmcnt(15)
  v_mfma_f32_32x32x16_bf16 v[24:39], v[80:83], v[60:63], v[24:39]
  v_mfma_f32_32x32x16_bf16 v[40:55], v[84:87], v[60:63], v[40:55]
  ds_read_b64_tr_b16 v[80:81], v136 offset:2048
  ds_read_b64_tr_b16 v[82:83], v136 offset:2560
  ds_read_b64_tr_b16 v[84:85], v137 offset:2048
  ds_read_b64_tr_b16 v[86:87], v137 offset:2560
  ds_read_b128 v[60:63], v109 offset:0
  s_waitcnt lgkmcnt(15)
  v_mfma_f32_32x32x16_bf16 v[24:39], v[88:91], v[64:67], v[24:39]
  v_mfma_f32_32x32x16_bf16 v[40:55], v[92:95], v[64:67], v[40:55]
  ds_read_b64_tr_b16 v[88:89], v136 offset:4096
  ds_read_b64_tr_b16 v[90:91], v136 offset:4608
  ds_read_b64_tr_b16 v[92:93], v137 offset:4096
  ds_read_b64_tr_b16 v[94:95], v137 offset:4608
  ds_read_b128 v[64:67], v110 offset:0
  s_waitcnt lgkmcnt(15)
  v_mfma_f32_32x32x16_bf16 v[24:39], v[96:99], v[68:71], v[24:39]
  v_mfma_f32_32x32x16_bf16 v[40:55], v[100:103], v[68:71], v[40:55]
  s_barrier
  ds_read_b64_tr_b16 v[96:97], v136 offset:6144
  ds_read_b64_tr_b16 v[98:99], v136 offset:6656
  ds_read_b64_tr_b16 v[100:101], v137 offset:6144
  ds_read_b64_tr_b16 v[102:103], v137 offset:6656
  ds_read_b128 v[68:71], v111 offset:0
  s_waitcnt lgkmcnt(15)
  v_mfma_f32_32x32x16_bf16 v[24:39], v[72:75], v[56:59], v[24:39]
  v_mfma_f32_32x32x16_bf16 v[40:55], v[76:79], v[56:59], v[40:55]
  ds_read_b64_tr_b16 v[72:73], v138 offset:0
  ds_read_b64_tr_b16 v[74:75], v138 offset:512
  ds_read_b64_tr_b16 v[76:77], v139 offset:0
  ds_read_b64_tr_b16 v[78:79], v139 offset:512
  ds_read_b128 v[56:59], v112 offset:0
  s_waitcnt lgkmcnt(15)
  v_mfma_f32_32x32x16_bf16 v[24:39], v[80:83], v[60:63], v[24:39]
  v_mfma_f32_32x32x16_bf16 v[40:55], v[84:87], v[60:63], v[40:55]
  ds_read_b64_tr_b16 v[80:81], v138 offset:2048
  ds_read_b64_tr_b16 v[82:83], v138 offset:2560
  ds_read_b64_tr_b16 v[84:85], v139 offset:2048
  ds_read_b64_tr_b16 v[86:87], v139 offset:2560
  ds_read_b128 v[60:63], v113 offset:0
  s_waitcnt lgkmcnt(15)
  v_mfma_f32_32x32x16_bf16 v[24:39], v[88:91], v[64:67], v[24:39]
  v_mfma_f32_32x32x16_bf16 v[40:55], v[92:95], v[64:67], v[40:55]
  ds_read_b64_tr_b16 v[88:89], v138 offset:4096
  ds_read_b64_tr_b16 v[90:91], v138 offset:4608
  ds_read_b64_tr_b16 v[92:93], v139 offset:4096
  ds_read_b64_tr_b16 v[94:95], v139 offset:4608
  ds_read_b128 v[64:67], v114 offset:0
  s_waitcnt lgkmcnt(15)
  v_mfma_f32_32x32x16_bf16 v[24:39], v[96:99], v[68:71], v[24:39]
  v_mfma_f32_32x32x16_bf16 v[40:55], v[100:103], v[68:71], v[40:55]
  s_barrier
  ds_read_b64_tr_b16 v[96:97], v138 offset:6144
  ds_read_b64_tr_b16 v[98:99], v138 offset:6656
  ds_read_b64_tr_b16 v[100:101], v139 offset:6144
  ds_read_b64_tr_b16 v[102:103], v139 offset:6656
  ds_read_b128 v[68:71], v115 offset:0
  s_waitcnt lgkmcnt(15)
  v_mfma_f32_32x32x16_bf16 v[24:39], v[72:75], v[56:59], v[24:39]
  v_mfma_f32_32x32x16_bf16 v[40:55], v[76:79], v[56:59], v[40:55]
  ds_read_b64_tr_b16 v[72:73], v140 offset:0
  ds_read_b64_tr_b16 v[74:75], v140 offset:512
  ds_read_b64_tr_b16 v[76:77], v141 offset:0
  ds_read_b64_tr_b16 v[78:79], v141 offset:512
  ds_read_b128 v[56:59], v116 offset:0
  s_waitcnt lgkmcnt(15)
  v_mfma_f32_32x32x16_bf16 v[24:39], v[80:83], v[60:63], v[24:39]
  v_mfma_f32_32x32x16_bf16 v[40:55], v[84:87], v[60:63], v[40:55]
  ds_read_b64_tr_b16 v[80:81], v140 offset:2048
  ds_read_b64_tr_b16 v[82:83], v140 offset:2560
  ds_read_b64_tr_b16 v[84:85], v141 offset:2048
  ds_read_b64_tr_b16 v[86:87], v141 offset:2560
  ds_read_b128 v[60:63], v117 offset:0
  s_waitcnt lgkmcnt(15)
  v_mfma_f32_32x32x16_bf16 v[24:39], v[88:91], v[64:67], v[24:39]
  v_mfma_f32_32x32x16_bf16 v[40:55], v[92:95], v[64:67], v[40:55]
  ds_read_b64_tr_b16 v[88:89], v140 offset:4096
  ds_read_b64_tr_b16 v[90:91], v140 offset:4608
  ds_read_b64_tr_b16 v[92:93], v141 offset:4096
  ds_read_b64_tr_b16 v[94:95], v141 offset:4608
  ds_read_b128 v[64:67], v118 offset:0
  s_waitcnt lgkmcnt(15)
  v_mfma_f32_32x32x16_bf16 v[24:39], v[96:99], v[68:71], v[24:39]
  v_mfma_f32_32x32x16_bf16 v[40:55], v[100:103], v[68:71], v[40:55]
  s_barrier
  ds_read_b64_tr_b16 v[96:97], v140 offset:6144
  ds_read_b64_tr_b16 v[98:99], v140 offset:6656
  ds_read_b64_tr_b16 v[100:101], v141 offset:6144
  ds_read_b64_tr_b16 v[102:103], v141 offset:6656
  ds_read_b128 v[68:71], v119 offset:0
  s_waitcnt lgkmcnt(15)
  v_mfma_f32_32x32x16_bf16 v[24:39], v[72:75], v[56:59], v[24:39]
  v_mfma_f32_32x32x16_bf16 v[40:55], v[76:79], v[56:59], v[40:55]
  ds_read_b64_tr_b16 v[72:73], v142 offset:0
  ds_read_b64_tr_b16 v[74:75], v142 offset:512
  ds_read_b64_tr_b16 v[76:77], v143 offset:0
  ds_read_b64_tr_b16 v[78:79], v143 offset:512
  ds_read_b128 v[56:59], v120 offset:0
  s_waitcnt lgkmcnt(15)
  v_mfma_f32_32x32x16_bf16 v[24:39], v[80:83], v[60:63], v[24:39]
  v_mfma_f32_32x32x16_bf16 v[40:55], v[84:87], v[60:63], v[40:55]
  ds_read_b64_tr_b16 v[80:81], v142 offset:2048
  ds_read_b64_tr_b16 v[82:83], v142 offset:2560
  ds_read_b64_tr_b16 v[84:85], v143 offset:2048
  ds_read_b64_tr_b16 v[86:87], v143 offset:2560
  ds_read_b128 v[60:63], v121 offset:0
  s_waitcnt lgkmcnt(15)
  v_mfma_f32_32x32x16_bf16 v[24:39], v[88:91], v[64:67], v[24:39]
  v_mfma_f32_32x32x16_bf16 v[40:55], v[92:95], v[64:67], v[40:55]
  ds_read_b64_tr_b16 v[88:89], v142 offset:4096
  ds_read_b64_tr_b16 v[90:91], v142 offset:4608
  ds_read_b64_tr_b16 v[92:93], v143 offset:4096
  ds_read_b64_tr_b16 v[94:95], v143 offset:4608
  ds_read_b128 v[64:67], v122 offset:0
  s_waitcnt lgkmcnt(15)
  v_mfma_f32_32x32x16_bf16 v[24:39], v[96:99], v[68:71], v[24:39]
  v_mfma_f32_32x32x16_bf16 v[40:55], v[100:103], v[68:71], v[40:55]
  s_barrier
  ds_read_b64_tr_b16 v[96:97], v142 offset:6144
  ds_read_b64_tr_b16 v[98:99], v142 offset:6656
  ds_read_b64_tr_b16 v[100:101], v143 offset:6144
  ds_read_b64_tr_b16 v[102:103], v143 offset:6656
  ds_read_b128 v[68:71], v123 offset:0
  s_waitcnt lgkmcnt(15)
  v_mfma_f32_32x32x16_bf16 v[24:39], v[72:75], v[56:59], v[24:39]
  v_mfma_f32_32x32x16_bf16 v[40:55], v[76:79], v[56:59], v[40:55]
  s_waitcnt lgkmcnt(10)
  v_mfma_f32_32x32x16_bf16 v[24:39], v[80:83], v[60:63], v[24:39]
  v_mfma_f32_32x32x16_bf16 v[40:55], v[84:87], v[60:63], v[40:55]
  s_waitcnt lgkmcnt(5)
  v_mfma_f32_32x32x16_bf16 v[24:39], v[88:91], v[64:67], v[24:39]
  v_mfma_f32_32x32x16_bf16 v[40:55], v[92:95], v[64:67], v[40:55]
  s_waitcnt lgkmcnt(0)
  v_mfma_f32_32x32x16_bf16 v[24:39], v[96:99], v[68:71], v[24:39]
  v_mfma_f32_32x32x16_bf16 v[40:55], v[100:103], v[68:71], v[40:55]
  s_barrier
  s_nop 11
  ds_write_b128 v106, v[24:27] offset:0
  ds_write_b128 v106, v[28:31] offset:32
  ds_write_b128 v106, v[32:35] offset:64
  ds_write_b128 v106, v[36:39] offset:96
  ds_write_b128 v106, v[40:43] offset:128
  ds_write_b128 v106, v[44:47] offset:160
  ds_write_b128 v106, v[48:51] offset:192
  ds_write_b128 v106, v[52:55] offset:224
gemm2_kernel_epi:
  s_waitcnt vmcnt(0) lgkmcnt(0)
  s_barrier
  ds_read_b128 v[20:23], v8 offset:0
  ds_read_b128 v[24:27], v8 offset:16
  ds_read_b128 v[28:31], v8 offset:17408
  ds_read_b128 v[32:35], v8 offset:17424
  v_lshlrev_b32 v52, 16, v18
  v_lshlrev_b32 v53, 16, v18
  v_lshlrev_b32 v36, 16, v10
  v_and_b32 v37, 0xffff0000, v10
  v_lshlrev_b32 v38, 16, v11
  v_and_b32 v39, 0xffff0000, v11
  v_lshlrev_b32 v40, 16, v12
  v_and_b32 v41, 0xffff0000, v12
  v_lshlrev_b32 v42, 16, v13
  v_and_b32 v43, 0xffff0000, v13
  v_lshlrev_b32 v54, 16, v19
  v_lshlrev_b32 v55, 16, v19
  v_lshlrev_b32 v44, 16, v14
  v_and_b32 v45, 0xffff0000, v14
  v_lshlrev_b32 v46, 16, v15
  v_and_b32 v47, 0xffff0000, v15
  v_lshlrev_b32 v48, 16, v16
  v_and_b32 v49, 0xffff0000, v16
  v_lshlrev_b32 v50, 16, v17
  v_and_b32 v51, 0xffff0000, v17
  s_waitcnt lgkmcnt(0)
  v_cvt_pk_bf16_f32 v56, v20, v21
  v_cvt_pk_bf16_f32 v57, v22, v23
  v_cvt_pk_bf16_f32 v58, v24, v25
  v_cvt_pk_bf16_f32 v59, v26, v27
  v_cvt_pk_bf16_f32 v60, v28, v29
  v_cvt_pk_bf16_f32 v61, v30, v31
  v_cvt_pk_bf16_f32 v62, v32, v33
  v_cvt_pk_bf16_f32 v63, v34, v35
  v_lshlrev_b32 v20, 16, v56
  v_and_b32 v21, 0xffff0000, v56
  v_lshlrev_b32 v22, 16, v57
  v_and_b32 v23, 0xffff0000, v57
  v_lshlrev_b32 v24, 16, v58
  v_and_b32 v25, 0xffff0000, v58
  v_lshlrev_b32 v26, 16, v59
  v_and_b32 v27, 0xffff0000, v59
  v_lshlrev_b32 v28, 16, v60
  v_and_b32 v29, 0xffff0000, v60
  v_lshlrev_b32 v30, 16, v61
  v_and_b32 v31, 0xffff0000, v61
  v_lshlrev_b32 v32, 16, v62
  v_and_b32 v33, 0xffff0000, v62
  v_lshlrev_b32 v34, 16, v63
  v_and_b32 v35, 0xffff0000, v63
  v_pk_add_f32 v[20:21], v[20:21], v[52:53]
  v_pk_add_f32 v[22:23], v[22:23], v[52:53]
  v_pk_add_f32 v[24:25], v[24:25], v[52:53]
  v_pk_add_f32 v[26:27], v[26:27], v[52:53]
  v_pk_add_f32 v[28:29], v[28:29], v[54:55]
  v_pk_add_f32 v[30:31], v[30:31], v[54:55]
  v_pk_add_f32 v[32:33], v[32:33], v[54:55]
  v_pk_add_f32 v[34:35], v[34:35], v[54:55]
  v_cvt_pk_bf16_f32 v56, v20, v21
  v_cvt_pk_bf16_f32 v57, v22, v23
  v_cvt_pk_bf16_f32 v58, v24, v25
  v_cvt_pk_bf16_f32 v59, v26, v27
  v_cvt_pk_bf16_f32 v60, v28, v29
  v_cvt_pk_bf16_f32 v61, v30, v31
  v_cvt_pk_bf16_f32 v62, v32, v33
  v_cvt_pk_bf16_f32 v63, v34, v35
  v_lshlrev_b32 v20, 16, v56
  v_and_b32 v21, 0xffff0000, v56
  v_lshlrev_b32 v22, 16, v57
  v_and_b32 v23, 0xffff0000, v57
  v_lshlrev_b32 v24, 16, v58
  v_and_b32 v25, 0xffff0000, v58
  v_lshlrev_b32 v26, 16, v59
  v_and_b32 v27, 0xffff0000, v59
  v_lshlrev_b32 v28, 16, v60
  v_and_b32 v29, 0xffff0000, v60
  v_lshlrev_b32 v30, 16, v61
  v_and_b32 v31, 0xffff0000, v61
  v_lshlrev_b32 v32, 16, v62
  v_and_b32 v33, 0xffff0000, v62
  v_lshlrev_b32 v34, 16, v63
  v_and_b32 v35, 0xffff0000, v63
  v_pk_mul_f32 v[20:21], v[20:21], v[36:37]
  v_pk_mul_f32 v[22:23], v[22:23], v[38:39]
  v_pk_mul_f32 v[24:25], v[24:25], v[40:41]
  v_pk_mul_f32 v[26:27], v[26:27], v[42:43]
  v_pk_mul_f32 v[28:29], v[28:29], v[44:45]
  v_pk_mul_f32 v[30:31], v[30:31], v[46:47]
  v_pk_mul_f32 v[32:33], v[32:33], v[48:49]
  v_pk_mul_f32 v[34:35], v[34:35], v[50:51]
  v_cvt_pk_bf16_f32 v56, v20, v21
  v_cvt_pk_bf16_f32 v57, v22, v23
  v_cvt_pk_bf16_f32 v58, v24, v25
  v_cvt_pk_bf16_f32 v59, v26, v27
  v_cvt_pk_bf16_f32 v60, v28, v29
  v_cvt_pk_bf16_f32 v61, v30, v31
  v_cvt_pk_bf16_f32 v62, v32, v33
  v_cvt_pk_bf16_f32 v63, v34, v35
  s_mov_b32 s56, 0
  buffer_store_dwordx4 v[56:59], v9, s[16:19], s56 offen sc1
  s_mov_b32 s56, 114688
  buffer_store_dwordx4 v[60:63], v9, s[16:19], s56 offen sc1
gemm2_kernel_end:
  s_endpgm
.globl gemm3_kernel
.p2align 8
.type gemm3_kernel,@function
gemm3_kernel:
  s_cmp_ge_u32 s2, 224
  s_cbranch_scc1 gemm3_kernel_end
  s_load_dwordx16 s[32:47], s[0:1], 0
  s_and_b32 s56, s2, 7
  s_lshr_b32 s57, s2, 3
  s_and_b32 s48, s57, 3
  s_lshr_b32 s49, s57, 2
  s_lshl_b32 s58, s56, 2
  s_add_u32 s48, s48, s58
  v_and_b32 v1, 63, v0
  v_lshrrev_b32 v2, 6, v0
  s_nop 0
  v_readfirstlane_b32 s50, v2
  v_and_b32 v2, 3, v2
  s_mov_b32 s59, s50
  s_cmp_lt_u32 s50, 4
  s_cbranch_scc1 gemm3_kernel_cons
  s_sub_u32 s50, s50, 4
  s_mul_i32 s56, s48, 114688
  s_mov_b32 s57, 1792
  v_lshrrev_b32 v3, 4, v1
  v_mul_u32_u24 v4, 16, v2
  v_add3_u32 v3, v3, v4, 0
  v_and_b32 v4, 15, v3
  v_and_b32 v5, 15, v1
  v_xor_b32 v5, v5, v4
  v_lshlrev_b32 v5, 4, v5
  v_mul_lo_u32 v3, v3, s57
  v_add3_u32 v10, v3, v5, s56
  v_lshrrev_b32 v3, 4, v1
  v_mul_u32_u24 v4, 16, v2
  v_add3_u32 v3, v3, v4, 4
  v_and_b32 v4, 15, v3
  v_and_b32 v5, 15, v1
  v_xor_b32 v5, v5, v4
  v_lshlrev_b32 v5, 4, v5
  v_mul_lo_u32 v3, v3, s57
  v_add3_u32 v11, v3, v5, s56
  v_lshrrev_b32 v3, 4, v1
  v_mul_u32_u24 v4, 16, v2
  v_add3_u32 v3, v3, v4, 8
  v_and_b32 v4, 15, v3
  v_and_b32 v5, 15, v1
  v_xor_b32 v5, v5, v4
  v_lshlrev_b32 v5, 4, v5
  v_mul_lo_u32 v3, v3, s57
  v_add3_u32 v12, v3, v5, s56
  v_lshrrev_b32 v3, 4, v1
  v_mul_u32_u24 v4, 16, v2
  v_add3_u32 v3, v3, v4, 12
  v_and_b32 v4, 15, v3
  v_and_b32 v5, 15, v1
  v_xor_b32 v5, v5, v4
  v_lshlrev_b32 v5, 4, v5
  v_mul_lo_u32 v3, v3, s57
  v_add3_u32 v13, v3, v5, s56
  s_mul_i32 s56, s49, 128
  s_mov_b32 s57, 896
  v_lshrrev_b32 v3, 3, v1
  v_mul_u32_u24 v4, 32, v2
  v_add3_u32 v3, v3, v4, 0
  v_bfe_u32 v4, v3, 1, 1
  v_lshlrev_b32 v4, 2, v4
  v_and_b32 v5, 7, v1
  v_xor_b32 v5, v5, v4
  v_lshlrev_b32 v5, 4, v5
  v_mul_lo_u32 v3, v3, s57
  v_add3_u32 v14, v3, v5, s56
  v_lshrrev_b32 v3, 3, v1
  v_mul_u32_u24 v4, 32, v2
  v_add3_u32 v3, v3, v4, 8
  v_bfe_u32 v4, v3, 1, 1
  v_lshlrev_b32 v4, 2, v4
  v_and_b32 v5, 7, v1
  v_xor_b32 v5, v5, v4
  v_lshlrev_b32 v5, 4, v5
  v_mul_lo_u32 v3, v3, s57
  v_add3_u32 v15, v3, v5, s56
  v_lshrrev_b32 v3, 3, v1
  v_mul_u32_u24 v4, 32, v2
  v_add3_u32 v3, v3, v4, 16
  v_bfe_u32 v4, v3, 1, 1
  v_lshlrev_b32 v4, 2, v4
  v_and_b32 v5, 7, v1
  v_xor_b32 v5, v5, v4
  v_lshlrev_b32 v5, 4, v5
  v_mul_lo_u32 v3, v3, s57
  v_add3_u32 v16, v3, v5, s56
  v_lshrrev_b32 v3, 3, v1
  v_mul_u32_u24 v4, 32, v2
  v_add3_u32 v3, v3, v4, 24
  v_bfe_u32 v4, v3, 1, 1
  v_lshlrev_b32 v4, 2, v4
  v_and_b32 v5, 7, v1
  v_xor_b32 v5, v5, v4
  v_lshlrev_b32 v5, 4, v5
  v_mul_lo_u32 v3, v3, s57
  v_add3_u32 v17, v3, v5, s56
  s_mul_i32 s53, s50, 4096
  s_mul_i32 s54, s50, 4096
  s_add_u32 s54, s54, 81920
  s_mov_b32 s51, 0
  s_mov_b32 s52, 0
  s_waitcnt lgkmcnt(0)
  s_add_u32 s8, s46, 0x900000
  s_addc_u32 s9, s47, 0
  s_and_b32 s9, s9, 0xffff
  s_mov_b32 s10, 0x380000
  s_mov_b32 s11, 0x20000
  s_mov_b32 s12, s40
  s_mov_b32 s13, s41
  s_and_b32 s13, s13, 0xffff
  s_mov_b32 s14, 0xc4000
  s_mov_b32 s15, 0x20000
  s_mov_b32 s16, s42
  s_mov_b32 s17, s43
  s_and_b32 s17, s17, 0xffff
  s_mov_b32 s18, 0x1c0000
  s_mov_b32 s19, 0x20000
  s_add_u32 m0, s53, 0
  s_nop 0
  buffer_load_dwordx4 v10, s[8:11], s51 offen lds
  s_add_u32 m0, s53, 1024
  s_nop 0
  buffer_load_dwordx4 v11, s[8:11], s51 offen lds
  s_add_u32 m0, s53, 2048
  s_nop 0
  buffer_load_dwordx4 v12, s[8:11], s51 offen lds
  s_add_u32 m0, s53, 3072
  s_nop 0
  buffer_load_dwordx4 v13, s[8:11], s51 offen lds
  s_add_u32 s51, s51, 256
  s_add_u32 m0, s54, 0
  s_nop 0
  buffer_load_dwordx4 v14, s[12:15], s52 offen lds
  s_add_u32 m0, s54, 1024
  s_nop 0
  buffer_load_dwordx4 v15, s[12:15], s52 offen lds
  s_add_u32 m0, s54, 2048
  s_nop 0
  buffer_load_dwordx4 v16, s[12:15], s52 offen lds
  s_add_u32 m0, s54, 3072
  s_nop 0
  buffer_load_dwordx4 v17, s[12:15], s52 offen lds
  s_add_u32 s52, s52, 114688
  s_add_u32 m0, s53, 16384
  s_nop 0
  buffer_load_dwordx4 v10, s[8:11], s51 offen lds
  s_add_u32 m0, s53, 17408
  s_nop 0
  buffer_load_dwordx4 v11, s[8:11], s51 offen lds
  s_add_u32 m0, s53, 18432
  s_nop 0
  buffer_load_dwordx4 v12, s[8:11], s51 offen lds
  s_add_u32 m0, s53, 19456
  s_nop 0
  buffer_load_dwordx4 v13, s[8:11], s51 offen lds
  s_add_u32 s51, s51, 256
  s_add_u32 m0, s54, 16384
  s_nop 0
  buffer_load_dwordx4 v14, s[12:15], s52 offen lds
  s_add_u32 m0, s54, 17408
  s_nop 0
  buffer_load_dwordx4 v15, s[12:15], s52 offen lds
  s_add_u32 m0, s54, 18432
  s_nop 0
  buffer_load_dwordx4 v16, s[12:15], s52 offen lds
  s_add_u32 m0, s54, 19456
  s_nop 0
  buffer_load_dwordx4 v17, s[12:15], s52 offen lds
  s_add_u32 s52, s52, 114688
  s_add_u32 m0, s53, 32768
  s_nop 0
  buffer_load_dwordx4 v10, s[8:11], s51 offen lds
  s_add_u32 m0, s53, 33792
  s_nop 0
  buffer_load_dwordx4 v11, s[8:11], s51 offen lds
  s_add_u32 m0, s53, 34816
  s_nop 0
  buffer_load_dwordx4 v12, s[8:11], s51 offen lds
  s_add_u32 m0, s53, 35840
  s_nop 0
  buffer_load_dwordx4 v13, s[8:11], s51 offen lds
  s_add_u32 s51, s51, 256
  s_add_u32 m0, s54, 32768
  s_nop 0
  buffer_load_dwordx4 v14, s[12:15], s52 offen lds
  s_add_u32 m0, s54, 33792
  s_nop 0
  buffer_load_dwordx4 v15, s[12:15], s52 offen lds
  s_add_u32 m0, s54, 34816
  s_nop 0
  buffer_load_dwordx4 v16, s[12:15], s52 offen lds
  s_add_u32 m0, s54, 35840
  s_nop 0
  buffer_load_dwordx4 v17, s[12:15], s52 offen lds
  s_add_u32 s52, s52, 114688
  s_add_u32 m0, s53, 49152
  s_nop 0
  buffer_load_dwordx4 v10, s[8:11], s51 offen lds
  s_add_u32 m0, s53, 50176
  s_nop 0
  buffer_load_dwordx4 v11, s[8:11], s51 offen lds
  s_add_u32 m0, s53, 51200
  s_nop 0
  buffer_load_dwordx4 v12, s[8:11], s51 offen lds
  s_add_u32 m0, s53, 52224
  s_nop 0
  buffer_load_dwordx4 v13, s[8:11], s51 offen lds
  s_add_u32 s51, s51, 256
  s_add_u32 m0, s54, 49152
  s_nop 0
  buffer_load_dwordx4 v14, s[12:15], s52 offen lds
  s_add_u32 m0, s54, 50176
  s_nop 0
  buffer_load_dwordx4 v15, s[12:15], s52 offen lds
  s_add_u32 m0, s54, 51200
  s_nop 0
  buffer_load_dwordx4 v16, s[12:15], s52 offen lds
  s_add_u32 m0, s54, 52224
  s_nop 0
  buffer_load_dwordx4 v17, s[12:15], s52 offen lds
  s_add_u32 s52, s52, 114688
  s_add_u32 m0, s53, 65536
  s_nop 0
  buffer_load_dwordx4 v10, s[8:11], s51 offen lds
  s_add_u32 m0, s53, 66560
  s_nop 0
  buffer_load_dwordx4 v11, s[8:11], s51 offen lds
  s_add_u32 m0, s53, 67584
  s_nop 0
  buffer_load_dwordx4 v12, s[8:11], s51 offen lds
  s_add_u32 m0, s53, 68608
  s_nop 0
  buffer_load_dwordx4 v13, s[8:11], s51 offen lds
  s_add_u32 s51, s51, 256
  s_add_u32 m0, s54, 65536
  s_nop 0
  buffer_load_dwordx4 v14, s[12:15], s52 offen lds
  s_add_u32 m0, s54, 66560
  s_nop 0
  buffer_load_dwordx4 v15, s[12:15], s52 offen lds
  s_add_u32 m0, s54, 67584
  s_nop 0
  buffer_load_dwordx4 v16, s[12:15], s52 offen lds
  s_add_u32 m0, s54, 68608
  s_nop 0
  buffer_load_dwordx4 v17, s[12:15], s52 offen lds
  s_add_u32 s52, s52, 114688
  v_lshrrev_b32 v7, 3, v0
  v_and_b32 v3, 7, v0
  v_mul_u32_u24 v4, 272, v7
  v_lshl_add_u32 v8, v3, 5, v4
  s_mul_i32 s56, s48, 64
  v_add_u32 v4, s56, v7
  s_mov_b32 s57, 896
  v_mul_lo_u32 v5, v4, s57
  s_mul_i32 s56, s49, 128
  v_lshl_add_u32 v6, v3, 4, v5
  v_add_u32 v9, s56, v6
  s_waitcnt vmcnt(24)
  s_barrier
  s_waitcnt vmcnt(16)
  s_barrier
  s_add_u32 m0, s53, 0
  s_nop 0
  buffer_load_dwordx4 v10, s[8:11], s51 offen lds
  s_add_u32 m0, s53, 1024
  s_nop 0
  buffer_load_dwordx4 v11, s[8:11], s51 offen lds
  s_add_u32 m0, s53, 2048
  s_nop 0
  buffer_load_dwordx4 v12, s[8:11], s51 offen lds
  s_add_u32 m0, s53, 3072
  s_nop 0
  buffer_load_dwordx4 v13, s[8:11], s51 offen lds
  s_add_u32 s51, s51, 256
  s_add_u32 m0, s54, 0
  s_nop 0
  buffer_load_dwordx4 v14, s[12:15], s52 offen lds
  s_add_u32 m0, s54, 1024
  s_nop 0
  buffer_load_dwordx4 v15, s[12:15], s52 offen lds
  s_add_u32 m0, s54, 2048
  s_nop 0
  buffer_load_dwordx4 v16, s[12:15], s52 offen lds
  s_add_u32 m0, s54, 3072
  s_nop 0
  buffer_load_dwordx4 v17, s[12:15], s52 offen lds
  s_add_u32 s52, s52, 114688
  s_waitcnt vmcnt(16)
  s_barrier
  s_add_u32 m0, s53, 16384
  s_nop 0
  buffer_load_dwordx4 v10, s[8:11], s51 offen lds
  s_add_u32 m0, s53, 17408
  s_nop 0
  buffer_load_dwordx4 v11, s[8:11], s51 offen lds
  s_add_u32 m0, s53, 18432
  s_nop 0
  buffer_load_dwordx4 v12, s[8:11], s51 offen lds
  s_add_u32 m0, s53, 19456
  s_nop 0
  buffer_load_dwordx4 v13, s[8:11], s51 offen lds
  s_add_u32 s51, s51, 256
  s_add_u32 m0, s54, 16384
  s_nop 0
  buffer_load_dwordx4 v14, s[12:15], s52 offen lds
  s_add_u32 m0, s54, 17408
  s_nop 0
  buffer_load_dwordx4 v15, s[12:15], s52 offen lds
  s_add_u32 m0, s54, 18432
  s_nop 0
  buffer_load_dwordx4 v16, s[12:15], s52 offen lds
  s_add_u32 m0, s54, 19456
  s_nop 0
  buffer_load_dwordx4 v17, s[12:15], s52 offen lds
  s_add_u32 s52, s52, 114688
  s_waitcnt vmcnt(16)
  s_barrier
  s_waitcnt vmcnt(8)
  s_barrier
  s_waitcnt vmcnt(0)
  s_barrier
  s_barrier
  s_barrier
  s_branch gemm3_kernel_epi
gemm3_kernel_cons:
  v_lshrrev_b32 v10, 1, v2
  v_and_b32 v11, 1, v2
  s_waitcnt lgkmcnt(0)
  s_mov_b32 s16, s42
  s_mov_b32 s17, s43
  s_and_b32 s17, s17, 0xffff
  s_mov_b32 s18, 0x1c0000
  s_mov_b32 s19, 0x20000
  v_lshrrev_b32 v7, 3, v0
  v_and_b32 v3, 7, v0
  v_mul_u32_u24 v4, 272, v7
  v_lshl_add_u32 v8, v3, 5, v4
  s_mul_i32 s56, s48, 64
  v_add_u32 v4, s56, v7
  s_mov_b32 s57, 896
  v_mul_lo_u32 v5, v4, s57
  s_mul_i32 s56, s49, 128
  v_lshl_add_u32 v6, v3, 4, v5
  v_add_u32 v9, s56, v6
  v_and_b32 v3, 31, v1
  v_mul_u32_u24 v4, 32, v10
  v_add_u32 v3, v3, v4
  v_mul_u32_u24 v77, 272, v3
  v_mul_u32_u24 v5, 128, v11
  v_add_u32 v77, v77, v5
  v_lshrrev_b32 v5, 5, v1
  v_lshl_add_u32 v77, v5, 4, v77
  v_and_b32 v4, 15, v3
  v_lshrrev_b32 v5, 5, v1
  v_xor_b32 v5, v5, v4
  v_lshlrev_b32 v5, 4, v5
  v_lshlrev_b32 v3, 8, v3
  v_add_u32 v76, v3, v5
  v_lshrrev_b32 v3, 5, v1
  v_lshlrev_b32 v3, 3, v3
  v_bfe_u32 v4, v1, 2, 2
  v_add_u32 v3, v3, v4
  v_lshrrev_b32 v4, 1, v4
  v_lshlrev_b32 v4, 2, v4
  v_mul_u32_u24 v5, 4, v11
  v_bfe_u32 v6, v1, 4, 1
  v_lshl_add_u32 v5, v6, 1, v5
  v_bfe_u32 v6, v1, 1, 1
  v_add_u32 v5, v5, v6
  v_xor_b32 v5, v5, v4
  v_lshlrev_b32 v5, 4, v5
  v_lshlrev_b32 v3, 7, v3
  v_add_u32 v3, v3, v5
  v_and_b32 v6, 1, v1
  v_lshl_add_u32 v78, v6, 3, v3
  v_add_u32 v78, 81920, v78
  v_xor_b32 v79, 0, v76
  v_xor_b32 v80, 32, v76
  v_xor_b32 v81, 64, v76
  v_xor_b32 v82, 96, v76
  v_xor_b32 v83, 128, v76
  v_xor_b32 v84, 160, v76
  v_xor_b32 v85, 192, v76
  v_xor_b32 v86, 224, v76
  v_xor_b32 v87, 0, v76
  v_add_u32 v87, 16384, v87
  v_xor_b32 v88, 32, v76
  v_add_u32 v88, 16384, v88
  v_xor_b32 v89, 64, v76
  v_add_u32 v89, 16384, v89
  v_xor_b32 v90, 96, v76
  v_add_u32 v90, 16384, v90
  v_xor_b32 v91, 128, v76
  v_add_u32 v91, 16384, v91
  v_xor_b32 v92, 160, v76
  v_add_u32 v92, 16384, v92
  v_xor_b32 v93, 192, v76
  v_add_u32 v93, 16384, v93
  v_xor_b32 v94, 224, v76
  v_add_u32 v94, 16384, v94
  v_xor_b32 v95, 0, v76
  v_add_u32 v95, 32768, v95
  v_xor_b32 v96, 32, v76
  v_add_u32 v96, 32768, v96
  v_xor_b32 v97, 64, v76
  v_add_u32 v97, 32768, v97
  v_xor_b32 v98, 96, v76
  v_add_u32 v98, 32768, v98
  v_xor_b32 v99, 128, v76
  v_add_u32 v99, 32768, v99
  v_xor_b32 v100, 160, v76
  v_add_u32 v100, 32768, v100
  v_xor_b32 v101, 192, v76
  v_add_u32 v101, 32768, v101
  v_xor_b32 v102, 224, v76
  v_add_u32 v102, 32768, v102
  v_xor_b32 v103, 0, v76
  v_add_u32 v103, 49152, v103
  v_xor_b32 v104, 32, v76
  v_add_u32 v104, 49152, v104
  v_xor_b32 v105, 64, v76
  v_add_u32 v105, 49152, v105
  v_xor_b32 v106, 96, v76
  v_add_u32 v106, 49152, v106
  v_xor_b32 v107, 128, v76
  v_add_u32 v107, 49152, v107
  v_xor_b32 v108, 160, v76
  v_add_u32 v108, 49152, v108
  v_xor_b32 v109, 192, v76
  v_add_u32 v109, 49152, v109
  v_xor_b32 v110, 224, v76
  v_add_u32 v110, 49152, v110
  v_xor_b32 v111, 0, v76
  v_add_u32 v111, 65536, v111
  v_xor_b32 v112, 32, v76
  v_add_u32 v112, 65536, v112
  v_xor_b32 v113, 64, v76
  v_add_u32 v113, 65536, v113
  v_xor_b32 v114, 96, v76
  v_add_u32 v114, 65536, v114
  v_xor_b32 v115, 128, v76
  v_add_u32 v115, 65536, v115
  v_xor_b32 v116, 160, v76
  v_add_u32 v116, 65536, v116
  v_xor_b32 v117, 192, v76
  v_add_u32 v117, 65536, v117
  v_xor_b32 v118, 224, v76
  v_add_u32 v118, 65536, v118
  v_xor_b32 v119, 0, v78
  v_xor_b32 v120, 0, v78
  v_add_u32 v120, 16384, v120
  v_xor_b32 v121, 0, v78
  v_add_u32 v121, 32768, v121
  v_xor_b32 v122, 0, v78
  v_add_u32 v122, 49152, v122
  v_xor_b32 v123, 0, v78
  v_add_u32 v123, 65536, v123
  v_mov_b32 v12, 0
  v_mov_b32 v13, 0
  v_mov_b32 v14, 0
  v_mov_b32 v15, 0
  v_mov_b32 v16, 0
  v_mov_b32 v17, 0
  v_mov_b32 v18, 0
  v_mov_b32 v19, 0
  v_mov_b32 v20, 0
  v_mov_b32 v21, 0
  v_mov_b32 v22, 0
  v_mov_b32 v23, 0
  v_mov_b32 v24, 0
  v_mov_b32 v25, 0
  v_mov_b32 v26, 0
  v_mov_b32 v27, 0
  s_barrier
  ds_read_b64_tr_b16 v[52:53], v119 offset:0
  ds_read_b64_tr_b16 v[54:55], v119 offset:512
  ds_read_b128 v[28:31], v79 offset:0
  ds_read_b64_tr_b16 v[56:57], v119 offset:2048
  ds_read_b64_tr_b16 v[58:59], v119 offset:2560
  ds_read_b128 v[32:35], v80 offset:0
  ds_read_b64_tr_b16 v[60:61], v119 offset:4096
  ds_read_b64_tr_b16 v[62:63], v119 offset:4608
  ds_read_b128 v[36:39], v81 offset:0
  ds_read_b64_tr_b16 v[64:65], v119 offset:6144
  ds_read_b64_tr_b16 v[66:67], v119 offset:6656
  ds_read_b128 v[40:43], v82 offset:0
  ds_read_b64_tr_b16 v[68:69], v119 offset:8192
  ds_read_b64_tr_b16 v[70:71], v119 offset:8704
  ds_read_b128 v[44:47], v83 offset:0
  ds_read_b64_tr_b16 v[72:73], v119 offset:10240
  ds_read_b64_tr_b16 v[74:75], v119 offset:10752
  ds_read_b128 v[48:51], v84 offset:0
  s_waitcnt lgkmcnt(15)
  v_mfma_f32_32x32x16_bf16 v[12:27], v[52:55], v[28:31], v[12:27]
  ds_read_b64_tr_b16 v[52:53], v119 offset:12288
  ds_read_b64_tr_b16 v[54:55], v119 offset:12800
  ds_read_b128 v[28:31], v85 offset:0
  s_waitcnt lgkmcnt(15)
  v_mfma_f32_32x32x16_bf16 v[12:27], v[56:59], v[32:35], v[12:27]
  ds_read_b64_tr_b16 v[56:57], v119 offset:14336
  ds_read_b64_tr_b16 v[58:59], v119 offset:14848
  ds_read_b128 v[32:35], v86 offset:0
  s_waitcnt lgkmcnt(15)
  v_mfma_f32_32x32x16_bf16 v[12:27], v[60:63], v[36:39], v[12:27]
  ds_read_b64_tr_b16 v[60:61], v120 offset:0
  ds_read_b64_tr_b16 v[62:63], v120 offset:512
  ds_read_b128 v[36:39], v87 offset:0
  s_waitcnt lgkmcnt(15)
  v_mfma_f32_32x32x16_bf16 v[12:27], v[64:67], v[40:43], v[12:27]
  ds_read_b64_tr_b16 v[64:65], v120 offset:2048
  ds_read_b64_tr_b16 v[66:67], v120 offset:2560
  ds_read_b128 v[40:43], v88 offset:0
  s_waitcnt lgkmcnt(15)
  v_mfma_f32_32x32x16_bf16 v[12:27], v[68:71], v[44:47], v[12:27]
  ds_read_b64_tr_b16 v[68:69], v120 offset:4096
  ds_read_b64_tr_b16 v[70:71], v120 offset:4608
  ds_read_b128 v[44:47], v89 offset:0
  s_waitcnt lgkmcnt(15)
  v_mfma_f32_32x32x16_bf16 v[12:27], v[72:75], v[48:51], v[12:27]
  ds_read_b64_tr_b16 v[72:73], v120 offset:6144
  ds_read_b64_tr_b16 v[74:75], v120 offset:6656
  ds_read_b128 v[48:51], v90 offset:0
  s_waitcnt lgkmcnt(15)
  v_mfma_f32_32x32x16_bf16 v[12:27], v[52:55], v[28:31], v[12:27]
  ds_read_b64_tr_b16 v[52:53], v120 offset:8192
  ds_read_b64_tr_b16 v[54:55], v120 offset:8704
  ds_read_b128 v[28:31], v91 offset:0
  s_waitcnt lgkmcnt(15)
  v_mfma_f32_32x32x16_bf16 v[12:27], v[56:59], v[32:35], v[12:27]
  s_barrier
  ds_read_b64_tr_b16 v[56:57], v120 offset:10240
  ds_read_b64_tr_b16 v[58:59], v120 offset:10752
  ds_read_b128 v[32:35], v92 offset:0
  s_waitcnt lgkmcnt(15)
  v_mfma_f32_32x32x16_bf16 v[12:27], v[60:63], v[36:39], v[12:27]
  ds_read_b64_tr_b16 v[60:61], v120 offset:12288
  ds_read_b64_tr_b16 v[62:63], v120 offset:12800
  ds_read_b128 v[36:39], v93 offset:0
  s_waitcnt lgkmcnt(15)
  v_mfma_f32_32x32x16_bf16 v[12:27], v[64:67], v[40:43], v[12:27]
  ds_read_b64_tr_b16 v[64:65], v120 offset:14336
  ds_read_b64_tr_b16 v[66:67], v120 offset:14848
  ds_read_b128 v[40:43], v94 offset:0
  s_waitcnt lgkmcnt(15)
  v_mfma_f32_32x32x16_bf16 v[12:27], v[68:71], v[44:47], v[12:27]
  ds_read_b64_tr_b16 v[68:69], v121 offset:0
  ds_read_b64_tr_b16 v[70:71], v121 offset:512
  ds_read_b128 v[44:47], v95 offset:0
  s_waitcnt lgkmcnt(15)
  v_mfma_f32_32x32x16_bf16 v[12:27], v[72:75], v[48:51], v[12:27]
  ds_read_b64_tr_b16 v[72:73], v121 offset:2048
  ds_read_b64_tr_b16 v[74:75], v121 offset:2560
  ds_read_b128 v[48:51], v96 offset:0
  s_waitcnt lgkmcnt(15)
  v_mfma_f32_32x32x16_bf16 v[12:27], v[52:55], v[28:31], v[12:27]
  ds_read_b64_tr_b16 v[52:53], v121 offset:4096
  ds_read_b64_tr_b16 v[54:55], v121 offset:4608
  ds_read_b128 v[28:31], v97 offset:0
  s_waitcnt lgkmcnt(15)
  v_mfma_f32_32x32x16_bf16 v[12:27], v[56:59], v[32:35], v[12:27]
  ds_read_b64_tr_b16 v[56:57], v121 offset:6144
  ds_read_b64_tr_b16 v[58:59], v121 offset:6656
  ds_read_b128 v[32:35], v98 offset:0
  s_waitcnt lgkmcnt(15)
  v_mfma_f32_32x32x16_bf16 v[12:27], v[60:63], v[36:39], v[12:27]
  ds_read_b64_tr_b16 v[60:61], v121 offset:8192
  ds_read_b64_tr_b16 v[62:63], v121 offset:8704
  ds_read_b128 v[36:39], v99 offset:0
  s_waitcnt lgkmcnt(15)
  v_mfma_f32_32x32x16_bf16 v[12:27], v[64:67], v[40:43], v[12:27]
  s_barrier
  ds_read_b64_tr_b16 v[64:65], v121 offset:10240
  ds_read_b64_tr_b16 v[66:67], v121 offset:10752
  ds_read_b128 v[40:43], v100 offset:0
  s_waitcnt lgkmcnt(15)
  v_mfma_f32_32x32x16_bf16 v[12:27], v[68:71], v[44:47], v[12:27]
  ds_read_b64_tr_b16 v[68:69], v121 offset:12288
  ds_read_b64_tr_b16 v[70:71], v121 offset:12800
  ds_read_b128 v[44:47], v101 offset:0
  s_waitcnt lgkmcnt(15)
  v_mfma_f32_32x32x16_bf16 v[12:27], v[72:75], v[48:51], v[12:27]
  ds_read_b64_tr_b16 v[72:73], v121 offset:14336
  ds_read_b64_tr_b16 v[74:75], v121 offset:14848
  ds_read_b128 v[48:51], v102 offset:0
  s_waitcnt lgkmcnt(15)
  v_mfma_f32_32x32x16_bf16 v[12:27], v[52:55], v[28:31], v[12:27]
  ds_read_b64_tr_b16 v[52:53], v122 offset:0
  ds_read_b64_tr_b16 v[54:55], v122 offset:512
  ds_read_b128 v[28:31], v103 offset:0
  s_waitcnt lgkmcnt(15)
  v_mfma_f32_32x32x16_bf16 v[12:27], v[56:59], v[32:35], v[12:27]
  ds_read_b64_tr_b16 v[56:57], v122 offset:2048
  ds_read_b64_tr_b16 v[58:59], v122 offset:2560
  ds_read_b128 v[32:35], v104 offset:0
  s_waitcnt lgkmcnt(15)
  v_mfma_f32_32x32x16_bf16 v[12:27], v[60:63], v[36:39], v[12:27]
  ds_read_b64_tr_b16 v[60:61], v122 offset:4096
  ds_read_b64_tr_b16 v[62:63], v122 offset:4608
  ds_read_b128 v[36:39], v105 offset:0
  s_waitcnt lgkmcnt(15)
  v_mfma_f32_32x32x16_bf16 v[12:27], v[64:67], v[40:43], v[12:27]
  ds_read_b64_tr_b16 v[64:65], v122 offset:6144
  ds_read_b64_tr_b16 v[66:67], v122 offset:6656
  ds_read_b128 v[40:43], v106 offset:0
  s_waitcnt lgkmcnt(15)
  v_mfma_f32_32x32x16_bf16 v[12:27], v[68:71], v[44:47], v[12:27]
  ds_read_b64_tr_b16 v[68:69], v122 offset:8192
  ds_read_b64_tr_b16 v[70:71], v122 offset:8704
  ds_read_b128 v[44:47], v107 offset:0
  s_waitcnt lgkmcnt(15)
  v_mfma_f32_32x32x16_bf16 v[12:27], v[72:75], v[48:51], v[12:27]
  s_barrier
  ds_read_b64_tr_b16 v[72:73], v122 offset:10240
  ds_read_b64_tr_b16 v[74:75], v122 offset:10752
  ds_read_b128 v[48:51], v108 offset:0
  s_waitcnt lgkmcnt(15)
  v_mfma_f32_32x32x16_bf16 v[12:27], v[52:55], v[28:31], v[12:27]
  ds_read_b64_tr_b16 v[52:53], v122 offset:12288
  ds_read_b64_tr_b16 v[54:55], v122 offset:12800
  ds_read_b128 v[28:31], v109 offset:0
  s_waitcnt lgkmcnt(15)
  v_mfma_f32_32x32x16_bf16 v[12:27], v[56:59], v[32:35], v[12:27]
  ds_read_b64_tr_b16 v[56:57], v122 offset:14336
  ds_read_b64_tr_b16 v[58:59], v122 offset:14848
  ds_read_b128 v[32:35], v110 offset:0
  s_waitcnt lgkmcnt(15)
  v_mfma_f32_32x32x16_bf16 v[12:27], v[60:63], v[36:39], v[12:27]
  ds_read_b64_tr_b16 v[60:61], v123 offset:0
  ds_read_b64_tr_b16 v[62:63], v123 offset:512
  ds_read_b128 v[36:39], v111 offset:0
  s_waitcnt lgkmcnt(15)
  v_mfma_f32_32x32x16_bf16 v[12:27], v[64:67], v[40:43], v[12:27]
  ds_read_b64_tr_b16 v[64:65], v123 offset:2048
  ds_read_b64_tr_b16 v[66:67], v123 offset:2560
  ds_read_b128 v[40:43], v112 offset:0
  s_waitcnt lgkmcnt(15)
  v_mfma_f32_32x32x16_bf16 v[12:27], v[68:71], v[44:47], v[12:27]
  ds_read_b64_tr_b16 v[68:69], v123 offset:4096
  ds_read_b64_tr_b16 v[70:71], v123 offset:4608
  ds_read_b128 v[44:47], v113 offset:0
  s_waitcnt lgkmcnt(15)
  v_mfma_f32_32x32x16_bf16 v[12:27], v[72:75], v[48:51], v[12:27]
  ds_read_b64_tr_b16 v[72:73], v123 offset:6144
  ds_read_b64_tr_b16 v[74:75], v123 offset:6656
  ds_read_b128 v[48:51], v114 offset:0
  s_waitcnt lgkmcnt(15)
  v_mfma_f32_32x32x16_bf16 v[12:27], v[52:55], v[28:31], v[12:27]
  ds_read_b64_tr_b16 v[52:53], v123 offset:8192
  ds_read_b64_tr_b16 v[54:55], v123 offset:8704
  ds_read_b128 v[28:31], v115 offset:0
  s_waitcnt lgkmcnt(15)
  v_mfma_f32_32x32x16_bf16 v[12:27], v[56:59], v[32:35], v[12:27]
  s_barrier
  ds_read_b64_tr_b16 v[56:57], v123 offset:10240
  ds_read_b64_tr_b16 v[58:59], v123 offset:10752
  ds_read_b128 v[32:35], v116 offset:0
  s_waitcnt lgkmcnt(15)
  v_mfma_f32_32x32x16_bf16 v[12:27], v[60:63], v[36:39], v[12:27]
  ds_read_b64_tr_b16 v[60:61], v123 offset:12288
  ds_read_b64_tr_b16 v[62:63], v123 offset:12800
  ds_read_b128 v[36:39], v117 offset:0
  s_waitcnt lgkmcnt(15)
  v_mfma_f32_32x32x16_bf16 v[12:27], v[64:67], v[40:43], v[12:27]
  ds_read_b64_tr_b16 v[64:65], v123 offset:14336
  ds_read_b64_tr_b16 v[66:67], v123 offset:14848
  ds_read_b128 v[40:43], v118 offset:0
  s_waitcnt lgkmcnt(15)
  v_mfma_f32_32x32x16_bf16 v[12:27], v[68:71], v[44:47], v[12:27]
  ds_read_b64_tr_b16 v[68:69], v119 offset:0
  ds_read_b64_tr_b16 v[70:71], v119 offset:512
  ds_read_b128 v[44:47], v79 offset:0
  s_waitcnt lgkmcnt(15)
  v_mfma_f32_32x32x16_bf16 v[12:27], v[72:75], v[48:51], v[12:27]
  ds_read_b64_tr_b16 v[72:73], v119 offset:2048
  ds_read_b64_tr_b16 v[74:75], v119 offset:2560
  ds_read_b128 v[48:51], v80 offset:0
  s_waitcnt lgkmcnt(15)
  v_mfma_f32_32x32x16_bf16 v[12:27], v[52:55], v[28:31], v[12:27]
  ds_read_b64_tr_b16 v[52:53], v119 offset:4096
  ds_read_b64_tr_b16 v[54:55], v119 offset:4608
  ds_read_b128 v[28:31], v81 offset:0
  s_waitcnt lgkmcnt(15)
  v_mfma_f32_32x32x16_bf16 v[12:27], v[56:59], v[32:35], v[12:27]
  ds_read_b64_tr_b16 v[56:57], v119 offset:6144
  ds_read_b64_tr_b16 v[58:59], v119 offset:6656
  ds_read_b128 v[32:35], v82 offset:0
  s_waitcnt lgkmcnt(15)
  v_mfma_f32_32x32x16_bf16 v[12:27], v[60:63], v[36:39], v[12:27]
  ds_read_b64_tr_b16 v[60:61], v119 offset:8192
  ds_read_b64_tr_b16 v[62:63], v119 offset:8704
  ds_read_b128 v[36:39], v83 offset:0
  s_waitcnt lgkmcnt(15)
  v_mfma_f32_32x32x16_bf16 v[12:27], v[64:67], v[40:43], v[12:27]
  s_barrier
  ds_read_b64_tr_b16 v[64:65], v119 offset:10240
  ds_read_b64_tr_b16 v[66:67], v119 offset:10752
  ds_read_b128 v[40:43], v84 offset:0
  s_waitcnt lgkmcnt(15)
  v_mfma_f32_32x32x16_bf16 v[12:27], v[68:71], v[44:47], v[12:27]
  ds_read_b64_tr_b16 v[68:69], v119 offset:12288
  ds_read_b64_tr_b16 v[70:71], v119 offset:12800
  ds_read_b128 v[44:47], v85 offset:0
  s_waitcnt lgkmcnt(15)
  v_mfma_f32_32x32x16_bf16 v[12:27], v[72:75], v[48:51], v[12:27]
  ds_read_b64_tr_b16 v[72:73], v119 offset:14336
  ds_read_b64_tr_b16 v[74:75], v119 offset:14848
  ds_read_b128 v[48:51], v86 offset:0
  s_waitcnt lgkmcnt(15)
  v_mfma_f32_32x32x16_bf16 v[12:27], v[52:55], v[28:31], v[12:27]
  ds_read_b64_tr_b16 v[52:53], v120 offset:0
  ds_read_b64_tr_b16 v[54:55], v120 offset:512
  ds_read_b128 v[28:31], v87 offset:0
  s_waitcnt lgkmcnt(15)
  v_mfma_f32_32x32x16_bf16 v[12:27], v[56:59], v[32:35], v[12:27]
  ds_read_b64_tr_b16 v[56:57], v120 offset:2048
  ds_read_b64_tr_b16 v[58:59], v120 offset:2560
  ds_read_b128 v[32:35], v88 offset:0
  s_waitcnt lgkmcnt(15)
  v_mfma_f32_32x32x16_bf16 v[12:27], v[60:63], v[36:39], v[12:27]
  ds_read_b64_tr_b16 v[60:61], v120 offset:4096
  ds_read_b64_tr_b16 v[62:63], v120 offset:4608
  ds_read_b128 v[36:39], v89 offset:0
  s_waitcnt lgkmcnt(15)
  v_mfma_f32_32x32x16_bf16 v[12:27], v[64:67], v[40:43], v[12:27]
  ds_read_b64_tr_b16 v[64:65], v120 offset:6144
  ds_read_b64_tr_b16 v[66:67], v120 offset:6656
  ds_read_b128 v[40:43], v90 offset:0
  s_waitcnt lgkmcnt(15)
  v_mfma_f32_32x32x16_bf16 v[12:27], v[68:71], v[44:47], v[12:27]
  ds_read_b64_tr_b16 v[68:69], v120 offset:8192
  ds_read_b64_tr_b16 v[70:71], v120 offset:8704
  ds_read_b128 v[44:47], v91 offset:0
  s_waitcnt lgkmcnt(15)
  v_mfma_f32_32x32x16_bf16 v[12:27], v[72:75], v[48:51], v[12:27]
  s_barrier
  ds_read_b64_tr_b16 v[72:73], v120 offset:10240
  ds_read_b64_tr_b16 v[74:75], v120 offset:10752
  ds_read_b128 v[48:51], v92 offset:0
  s_waitcnt lgkmcnt(15)
  v_mfma_f32_32x32x16_bf16 v[12:27], v[52:55], v[28:31], v[12:27]
  ds_read_b64_tr_b16 v[52:53], v120 offset:12288
  ds_read_b64_tr_b16 v[54:55], v120 offset:12800
  ds_read_b128 v[28:31], v93 offset:0
  s_waitcnt lgkmcnt(15)
  v_mfma_f32_32x32x16_bf16 v[12:27], v[56:59], v[32:35], v[12:27]
  ds_read_b64_tr_b16 v[56:57], v120 offset:14336
  ds_read_b64_tr_b16 v[58:59], v120 offset:14848
  ds_read_b128 v[32:35], v94 offset:0
  s_waitcnt lgkmcnt(15)
  v_mfma_f32_32x32x16_bf16 v[12:27], v[60:63], v[36:39], v[12:27]
  s_waitcnt lgkmcnt(12)
  v_mfma_f32_32x32x16_bf16 v[12:27], v[64:67], v[40:43], v[12:27]
  s_waitcnt lgkmcnt(9)
  v_mfma_f32_32x32x16_bf16 v[12:27], v[68:71], v[44:47], v[12:27]
  s_waitcnt lgkmcnt(6)
  v_mfma_f32_32x32x16_bf16 v[12:27], v[72:75], v[48:51], v[12:27]
  s_waitcnt lgkmcnt(3)
  v_mfma_f32_32x32x16_bf16 v[12:27], v[52:55], v[28:31], v[12:27]
  s_waitcnt lgkmcnt(0)
  v_mfma_f32_32x32x16_bf16 v[12:27], v[56:59], v[32:35], v[12:27]
  s_barrier
  s_nop 11
  ds_write_b128 v77, v[12:15] offset:0
  ds_write_b128 v77, v[16:19] offset:32
  ds_write_b128 v77, v[20:23] offset:64
  ds_write_b128 v77, v[24:27] offset:96
gemm3_kernel_epi:
  s_waitcnt lgkmcnt(0)
  s_barrier
  ds_read_b128 v[12:15], v8 offset:0
  ds_read_b128 v[16:19], v8 offset:16
  s_waitcnt lgkmcnt(0)
  v_cvt_pk_bf16_f32 v20, v12, v13
  v_cvt_pk_bf16_f32 v21, v14, v15
  v_cvt_pk_bf16_f32 v22, v16, v17
  v_cvt_pk_bf16_f32 v23, v18, v19
  s_mov_b32 s56, 0
  buffer_store_dwordx4 v[20:23], v9, s[16:19], s56 offen sc1
gemm3_kernel_end:
  s_endpgm
.section .rodata,"a"
.p2align 6
.amdhsa_kernel gemm1_kernel
  .amdhsa_next_free_vgpr 168
  .amdhsa_next_free_sgpr 96
  .amdhsa_accum_offset 168
  .amdhsa_group_segment_fixed_size 0
  .amdhsa_kernarg_size 64
  .amdhsa_user_sgpr_count 2
  .amdhsa_user_sgpr_kernarg_segment_ptr 1
  .amdhsa_system_sgpr_workgroup_id_x 1
  .amdhsa_float_denorm_mode_32 3
.end_amdhsa_kernel
.p2align 6
.amdhsa_kernel gemm2_kernel
  .amdhsa_next_free_vgpr 161
  .amdhsa_next_free_sgpr 96
  .amdhsa_accum_offset 164
  .amdhsa_group_segment_fixed_size 0
  .amdhsa_kernarg_size 64
  .amdhsa_user_sgpr_count 2
  .amdhsa_user_sgpr_kernarg_segment_ptr 1
  .amdhsa_system_sgpr_workgroup_id_x 1
  .amdhsa_float_denorm_mode_32 3
.end_amdhsa_kernel
.p2align 6
.amdhsa_kernel gemm3_kernel
  .amdhsa_next_free_vgpr 124
  .amdhsa_next_free_sgpr 96
  .amdhsa_accum_offset 124
  .amdhsa_group_segment_fixed_size 0
  .amdhsa_kernarg_size 64
  .amdhsa_user_sgpr_count 2
  .amdhsa_user_sgpr_kernarg_segment_ptr 1
  .amdhsa_system_sgpr_workgroup_id_x 1
  .amdhsa_float_denorm_mode_32 3
.end_amdhsa_kernel
```
